```python
import torch

def _softmax(x, axis=-1):
    return torch.softmax(x, dim=axis)
def _gelu(x):
    return torch.nn.functional.gelu(x, approximate="tanh")
def _silu(x):
    return torch.nn.functional.silu(x)
def _sigmoid(x):
    return torch.sigmoid(x)
def _layernorm(x, axis=-1, eps=1e-5):
    m = x.mean(dim=axis, keepdim=True)
    v = x.var(dim=axis, keepdim=True, unbiased=False)
    return (x - m) / torch.sqrt(v + eps)
def _scatter_add(tgt, idx, src, axis=0):
    return tgt.clone().index_add_(axis, idx, src)
def _segment_sum(src, seg, n):
    out = torch.zeros((n,) + src.shape[1:], dtype=src.dtype)
    return out.index_add_(0, seg, src)
def _pad(x, pw):
    flat = tuple(v for pair in reversed(pw) for v in pair)
    return torch.nn.functional.pad(x, flat)

kernel_name = 'interleave_layers__mha_block_cached__swiglu_ffn__decode'

def setup_inputs():

    _w = (lambda a: (lambda t: t.to(torch.bfloat16) if t.is_floating_point() else t)(torch.as_tensor(a)))
    def _A_setup():
        B, Sq, D = 1, 1, 512
        H, Sk, Dh = 32, 4096, 128
        return {
            "x": _w((lambda *s: torch.randn(*s, dtype=torch.bfloat16) * 0.05)(B, Sq, D)),
            "k_cache": _w((lambda *s: torch.randn(*s, dtype=torch.bfloat16) * 1.6)(B, H, Sk, Dh)),
            "v_cache": _w((lambda *s: torch.randn(*s, dtype=torch.bfloat16) * 1.6)(B, H, Sk, Dh)),
            "wq": _w((lambda *s: torch.randn(*s, dtype=torch.bfloat16) * 1.6)(D, H * Dh) * (D ** -0.5)),
            "wo": _w((lambda *s: torch.randn(*s, dtype=torch.bfloat16) * 1.6)(H * Dh, D) * ((H * Dh) ** -0.5)),
        }
    _A_in = _A_setup()

    def _B_setup():
        B, S, D, F = 1, 1, 512, 1376
        return {
            "x": _w((lambda *s: torch.randn(*s, dtype=torch.bfloat16) * 0.05)(B, S, D)),
            "w_gate": _w((lambda *s: torch.randn(*s, dtype=torch.bfloat16) * 0.05)(D, F)),
            "w_up": _w((lambda *s: torch.randn(*s, dtype=torch.bfloat16) * 0.05)(D, F)),
            "w_down": _w((lambda *s: torch.randn(*s, dtype=torch.bfloat16) * 0.05)(F, D)),
        }
    _B_in = _B_setup()

    return {
        "A_x": _A_in["x"],
        "A_k_cache": _A_in["k_cache"],
        "A_v_cache": _A_in["v_cache"],
        "A_wq": _A_in["wq"],
        "A_wo": _A_in["wo"],
        "B_x": _B_in["x"],
        "B_w_gate": _B_in["w_gate"],
        "B_w_up": _B_in["w_up"],
        "B_w_down": _B_in["w_down"],
    }

def reference(A_x, A_k_cache, A_v_cache, A_wq, A_wo, B_x, B_w_gate, B_w_up, B_w_down):
    def _A_ref(x, k_cache, v_cache, wq, wo):
        B, Sq, D = x.shape
        H, Dh = 32, 128
        q = (lambda x, *d: x.permute(*d))((x @ wq).reshape(B, Sq, H, Dh), 0, 2, 1, 3)
        scores = torch.einsum("bhqd,bhkd->bhqk", q, k_cache) * (Dh ** -0.5)
        p = _softmax(scores, axis=-1)
        o = torch.einsum("bhqk,bhkd->bhqd", p, v_cache)
        return (lambda x, *d: x.permute(*d))(o, 0, 2, 1, 3).reshape(B, Sq, H * Dh) @ wo

    def _B_ref(x, w_gate, w_up, w_down):
        g = _silu(x @ w_gate)
        u = x @ w_up
        return (g * u) @ w_down

    x = A_x
    x = x + _A_ref(_layernorm(x, axis=-1), A_k_cache, A_v_cache, A_wq, A_wo)
    x = x + _B_ref(_layernorm(x, axis=-1), B_w_gate, B_w_up, B_w_down)
    x = x + _A_ref(_layernorm(x, axis=-1), A_k_cache, A_v_cache, A_wq, A_wo)
    x = x + _B_ref(_layernorm(x, axis=-1), B_w_gate, B_w_up, B_w_down)
    return x
```

```asm
; @launch grid=(256,1,1) block=(512,1,1) lds=5632
.amdgcn_target "amdgcn-amd-amdhsa--gfx950"
.text
.globl interleave_layers__mha_block_cached__swiglu_ffn__decode_kernel
.p2align 8
.type interleave_layers__mha_block_cached__swiglu_ffn__decode_kernel,@function
interleave_layers__mha_block_cached__swiglu_ffn__decode_kernel:
    s_cmp_ge_u32 s2, 0x100
    s_cbranch_scc1 END
    s_load_dwordx2 s[8:9], s[0:1], 8
    s_load_dwordx2 s[12:13], s[0:1], 16
    s_load_dwordx2 s[16:17], s[0:1], 0
    s_load_dwordx2 s[20:21], s[0:1], 24
    s_load_dwordx2 s[44:45], s[0:1], 80
    s_load_dwordx2 s[48:49], s[0:1], 88
    v_lshrrev_b32 v1, 6, v0
    v_and_b32 v3, 63, v0
    s_and_b32 s4, s2, 7
    s_lshl_b32 s4, s4, 5
    v_readfirstlane_b32 s3, v1
    s_lshr_b32 s5, s2, 3
    s_add_u32 s4, s4, s5
    s_lshr_b32 s5, s4, 3
    s_and_b32 s6, s4, 7
    v_and_b32 v4, 15, v0
    v_bfe_u32 v5, v0, 4, 2
    v_lshlrev_b32 v25, 4, v3
    v_and_b32 v6, 7, v0
    v_bfe_u32 v7, v0, 3, 1
    v_lshlrev_b32 v30, 8, v6
    v_lshl_add_u32 v30, v7, 6, v30
    v_lshl_add_u32 v30, v5, 4, v30
    s_lshl_b32 s52, s4, 17
    s_lshr_b32 s60, s3, 2
    s_lshl_b32 s60, s60, 16
    s_add_u32 s52, s52, s60
    s_and_b32 s60, s3, 3
    s_lshl_b32 s60, s60, 11
    s_add_u32 s52, s52, s60
    s_add_u32 s53, s52, 8192
    s_add_u32 s54, s52, 16384
    s_add_u32 s55, s52, 24576
    s_add_u32 s56, s52, 32768
    s_add_u32 s57, s52, 40960
    s_add_u32 s58, s52, 49152
    s_add_u32 s59, s52, 57344
    s_mov_b32 s10, 33554432
    s_mov_b32 s11, 0x20000
    s_mov_b32 s14, 33554432
    s_mov_b32 s15, 0x20000
    s_mov_b32 s18, 1024
    s_mov_b32 s19, 0x20000
    s_mov_b32 s22, 4194304
    s_mov_b32 s23, 0x20000
    s_mov_b32 s46, 256
    s_mov_b32 s47, 0x20000
    s_mov_b32 s50, 1048576
    s_mov_b32 s51, 0x20000
    v_lshlrev_b32 v31, 4, v6
    v_lshl_add_u32 v31, v5, 2, v31
    v_bfe_u32 v12, v0, 4, 1
    v_bfe_u32 v13, v0, 5, 1
    s_lshl_b32 s83, s6, 7
    v_lshrrev_b32 v15, 1, v25
    v_and_b32 v15, 0xf8, v15
    s_cmp_eq_u32 s3, 3
    s_cbranch_scc1 LD_Q
    s_branch SETUP
LD_Q:
    s_mov_b32 s64, 0
    s_mov_b32 s65, 8192
    s_mov_b32 s66, 65536
    s_mov_b32 s67, 73728
    s_mov_b32 s68, 131072
    s_mov_b32 s69, 139264
    s_mov_b32 s70, 196608
    s_mov_b32 s71, 204800
    s_mov_b32 s72, 32768
    s_mov_b32 s73, 40960
    s_mov_b32 s74, 98304
    s_mov_b32 s75, 106496
    s_mov_b32 s76, 163840
    s_mov_b32 s77, 172032
    s_mov_b32 s78, 229376
    s_mov_b32 s79, 237568
    v_lshlrev_b32 v3, 1, v13
    v_lshl_add_u32 v3, v12, 5, v3
    v_lshlrev_b32 v3, 13, v3
    v_lshl_add_u32 v3, v4, 4, v3
    s_lshl_b32 s61, s6, 19
    s_lshl_b32 s60, s5, 8
    s_add_u32 s60, s60, s61
    v_add_u32 v3, s60, v3
    v_mov_b64 v[208:209], -1
    v_mov_b64 v[210:211], -1
    v_lshlrev_b32 v14, 4, v6
    v_bfe_u32 v16, v0, 3, 3
    v_lshl_add_u32 v16, v16, 12, v14
    s_lshl_b32 s62, s5, 11
    s_add_u32 s62, s62, 786432
    s_lshl_b32 s63, s5, 7
    s_add_u32 s61, s63, 98304
    s_add_u32 s63, s63, 851968
    v_lshlrev_b32 v9, 17, v5
    v_lshl_add_u32 v9, v4, 4, v9
    s_lshl_b32 s80, s4, 8
    s_add_u32 s60, s80, 524288
    v_add_u32 v10, s60, v9
    v_bfe_u32 v11, v0, 3, 2
    v_lshl_add_u32 v11, v11, 17, v14
    s_lshl_b32 s60, s6, 12
    s_add_u32 s60, s60, s61
    s_lshl_b32 s81, s4, 7
    s_add_u32 s81, s81, 65536
    s_mov_b32 exec_lo, 0
    v_add_u32 v10, s60, v11
    s_mov_b32 exec_hi, 0xff
    v_add_u32 v10, s81, v14
    s_mov_b64 exec, -1
    s_cmp_eq_u32 s6, 0
    s_waitcnt lgkmcnt(0)
    s_cbranch_scc0 NOCLR
    buffer_store_dwordx4 v[208:211], v25, s[48:51], s62 offen sc1
    buffer_store_dwordx4 v[208:211], v25, s[48:51], s62 offen offset:1024 sc1
    buffer_store_dwordx4 v[208:211], v16, s[48:51], s61 offen sc1
    buffer_store_dwordx4 v[208:211], v14, s[48:51], s63 offen sc1
NOCLR:
    buffer_load_dword v8, v31, s[16:19], s83 offen
    buffer_load_dwordx4 v[192:195], v25, s[16:19], 0 offen
    buffer_load_dwordx4 v[68:71], v3, s[20:23], s64 offen nt
    buffer_load_dwordx4 v[76:79], v3, s[20:23], s65 offen nt
    buffer_load_dwordx4 v[84:87], v3, s[20:23], s66 offen nt
    buffer_load_dwordx4 v[92:95], v3, s[20:23], s67 offen nt
    buffer_load_dwordx4 v[100:103], v3, s[20:23], s68 offen nt
    buffer_load_dwordx4 v[108:111], v3, s[20:23], s69 offen nt
    buffer_load_dwordx4 v[116:119], v3, s[20:23], s70 offen nt
    buffer_load_dwordx4 v[124:127], v3, s[20:23], s71 offen nt
    buffer_load_dwordx4 v[32:35], v3, s[20:23], s72 offen nt
    buffer_load_dwordx4 v[36:39], v3, s[20:23], s73 offen nt
    buffer_load_dwordx4 v[40:43], v3, s[20:23], s74 offen nt
    buffer_load_dwordx4 v[44:47], v3, s[20:23], s75 offen nt
    buffer_load_dwordx4 v[48:51], v3, s[20:23], s76 offen nt
    buffer_load_dwordx4 v[52:55], v3, s[20:23], s77 offen nt
    buffer_load_dwordx4 v[56:59], v3, s[20:23], s78 offen nt
    buffer_load_dwordx4 v[60:63], v3, s[20:23], s79 offen nt
    buffer_store_dwordx4 v[208:211], v9, s[48:51], s80 offen sc1
    buffer_store_dwordx4 v[208:211], v10, s[48:51], 0 offen sc1
    buffer_load_dwordx4 v[128:131], v30, s[8:11], s52 offen offset:0 nt
    buffer_load_dwordx4 v[136:139], v30, s[8:11], s52 offen offset:128 nt
    buffer_load_dwordx4 v[132:135], v30, s[8:11], s54 offen offset:0 nt
    buffer_load_dwordx4 v[140:143], v30, s[8:11], s54 offen offset:128 nt
    buffer_load_dwordx4 v[144:147], v30, s[8:11], s53 offen offset:0 nt
    buffer_load_dwordx4 v[152:155], v30, s[8:11], s53 offen offset:128 nt
    buffer_load_dwordx4 v[148:151], v30, s[8:11], s55 offen offset:0 nt
    buffer_load_dwordx4 v[156:159], v30, s[8:11], s55 offen offset:128 nt
    buffer_load_dwordx4 v[160:163], v30, s[8:11], s56 offen offset:0 nt
    buffer_load_dwordx4 v[168:171], v30, s[8:11], s56 offen offset:128 nt
    buffer_load_dwordx4 v[164:167], v30, s[8:11], s58 offen offset:0 nt
    buffer_load_dwordx4 v[172:175], v30, s[8:11], s58 offen offset:128 nt
    buffer_load_dwordx4 v[176:179], v30, s[8:11], s57 offen offset:0 nt
    buffer_load_dwordx4 v[184:187], v30, s[8:11], s57 offen offset:128 nt
    buffer_load_dwordx4 v[180:183], v30, s[8:11], s59 offen offset:0 nt
    buffer_load_dwordx4 v[188:191], v30, s[8:11], s59 offen offset:128 nt
SETUP:
    s_load_dwordx2 s[24:25], s[0:1], 32
    s_load_dwordx2 s[28:29], s[0:1], 48
    s_load_dwordx2 s[32:33], s[0:1], 56
    s_load_dwordx2 s[36:37], s[0:1], 64
    s_load_dwordx2 s[40:41], s[0:1], 72
    s_mov_b32 s62, 0x05040100
    s_mov_b32 s63, 0x07060302
    v_add_u32 v9, 1, v0
    v_bfe_u32 v9, v9, 1, 1
    v_mul_u32_u24 v1, 0xaaaa, v9
    v_or_b32 v1, 0x4444, v1
    v_lshlrev_b32 v9, 4, v9
    v_lshl_add_u32 v14, v5, 5, v9
    v_bfe_u32 v9, v0, 2, 1
    v_mul_u32_u24 v24, 0xaaaa, v9
    v_or_b32 v24, 0x4444, v24
    v_and_b32 v10, 1, v0
    v_lshlrev_b32 v9, 4, v10
    v_mov_b32 v11, 0x3f80
    v_lshlrev_b32 v9, v9, v11
    v_mul_lo_u32 v17, v9, v7
    v_sub_u32 v16, v9, v17
    v_mov_b32 v18, v16
    v_mov_b32 v19, v17
    v_mov_b32 v20, 0x3f803f80
    v_mov_b32 v21, v20
    v_mov_b32 v22, v20
    v_mov_b32 v23, v20
    v_lshl_add_u32 v26, v5, 1, v4
    v_and_b32 v26, 7, v26
    v_lshlrev_b32 v26, 7, v26
    v_lshrrev_b32 v27, 1, v4
    v_lshlrev_b32 v27, 5, v27
    v_lshl_add_u32 v27, v10, 3, v27
    v_lshl_add_u32 v27, v12, 4, v27
    v_lshl_add_u32 v27, v13, 2, v27
    s_lshl_b32 s60, s3, 8
    v_lshl_add_u32 v2, v4, 4, s60
    s_lshl_b32 s60, s3, 2
    s_add_u32 s60, s60, 4096
    v_writelane_b32 v2, s60, 63
    v_add_u32 v14, 2176, v14
    v_mul_u32_u24 v14, v10, v14
    v_add_u32 v0, 2176, v14
    s_mov_b64 s[64:65], -1
    s_mov_b64 s[66:67], 0xffff
    s_mov_b64 s[68:69], 1
    s_mov_b32 s70, 0
    s_brev_b32 s71, 1
    s_mov_b64 exec, s[64:65]
    s_mov_b32 s26, 4194304
    s_mov_b32 s27, 0x20000
    s_mov_b32 s30, 1409024
    s_mov_b32 s31, 0x20000
    s_mov_b32 s34, 1409024
    s_mov_b32 s35, 0x20000
    s_mov_b32 s38, 1409024
    s_mov_b32 s39, 0x20000
    s_mov_b32 s42, 1024
    s_mov_b32 s43, 0x20000
    s_add_u32 s60, s3, 1
    s_lshr_b32 s60, s60, 1
    s_lshl_b32 s61, s60, 5
    s_lshl_b32 s60, s60, 18
    s_lshl_b32 s75, s4, 8
    s_add_u32 s75, s75, s60
    s_lshl_b32 s77, s5, 11
    s_add_u32 s77, s77, s60
    s_add_u32 s61, s61, 65536
    s_lshl_b32 s76, s4, 7
    s_add_u32 s76, s76, s61
    s_lshl_b32 s78, s5, 10
    s_add_u32 s78, s78, s61
    s_and_b32 s60, s3, 2
    s_lshl_b32 s60, s60, 17
    s_lshl_b32 s74, s6, 12
    s_add_u32 s74, s74, s60
    s_add_u32 s74, s74, 98304
    s_lshl_b32 s60, s5, 7
    s_add_u32 s79, s74, s60
    s_mov_b32 s72, 0x40000
    s_mov_b32 s73, 0
    s_mov_b32 s80, 0
    s_cmp_lt_u32 s3, 4
    s_cselect_b32 s82, 1, 0
    s_cselect_b32 s81, 0, 1
    s_cbranch_scc1 PRE_A
    s_waitcnt lgkmcnt(0)
    s_add_u32 s60, s52, 0
    buffer_load_dwordx4 v[128:131], v30, s[8:11], s60 offen offset:0 nt
    buffer_load_dwordx4 v[136:139], v30, s[8:11], s60 offen offset:128 nt
    s_add_u32 s60, s52, 16384
    buffer_load_dwordx4 v[132:135], v30, s[8:11], s60 offen offset:0 nt
    buffer_load_dwordx4 v[140:143], v30, s[8:11], s60 offen offset:128 nt
    s_add_u32 s60, s52, 8192
    buffer_load_dwordx4 v[144:147], v30, s[8:11], s60 offen offset:0 nt
    buffer_load_dwordx4 v[152:155], v30, s[8:11], s60 offen offset:128 nt
    s_add_u32 s60, s52, 24576
    buffer_load_dwordx4 v[148:151], v30, s[8:11], s60 offen offset:0 nt
    buffer_load_dwordx4 v[156:159], v30, s[8:11], s60 offen offset:128 nt
    s_add_u32 s60, s52, 32768
    buffer_load_dwordx4 v[160:163], v30, s[8:11], s60 offen offset:0 nt
    buffer_load_dwordx4 v[168:171], v30, s[8:11], s60 offen offset:128 nt
    s_add_u32 s60, s52, 49152
    buffer_load_dwordx4 v[164:167], v30, s[8:11], s60 offen offset:0 nt
    buffer_load_dwordx4 v[172:175], v30, s[8:11], s60 offen offset:128 nt
    s_add_u32 s60, s52, 40960
    buffer_load_dwordx4 v[176:179], v30, s[8:11], s60 offen offset:0 nt
    buffer_load_dwordx4 v[184:187], v30, s[8:11], s60 offen offset:128 nt
    s_add_u32 s60, s52, 57344
    buffer_load_dwordx4 v[180:183], v30, s[8:11], s60 offen offset:0 nt
    buffer_load_dwordx4 v[188:191], v30, s[8:11], s60 offen offset:128 nt
    s_add_u32 s60, s52, 0
    buffer_load_dwordx4 v[196:199], v25, s[12:15], s60 offen offset:0 nt
    buffer_load_dwordx4 v[204:207], v25, s[12:15], s60 offen offset:1024 nt
    s_add_u32 s60, s52, 8192
    buffer_load_dwordx4 v[212:215], v25, s[12:15], s60 offen offset:0 nt
    buffer_load_dwordx4 v[220:223], v25, s[12:15], s60 offen offset:1024 nt
    s_add_u32 s60, s52, 16384
    buffer_load_dwordx4 v[228:231], v25, s[12:15], s60 offen offset:0 nt
    buffer_load_dwordx4 v[236:239], v25, s[12:15], s60 offen offset:1024 nt
    s_add_u32 s60, s52, 24576
    buffer_load_dwordx4 v[244:247], v25, s[12:15], s60 offen offset:0 nt
    buffer_load_dwordx4 v[252:255], v25, s[12:15], s60 offen offset:1024 nt
    s_add_u32 s60, s52, 32768
    buffer_load_dwordx4 v[64:67], v25, s[12:15], s60 offen offset:0 nt
    buffer_load_dwordx4 v[68:71], v25, s[12:15], s60 offen offset:1024 nt
    s_add_u32 s60, s52, 40960
    buffer_load_dwordx4 v[72:75], v25, s[12:15], s60 offen offset:0 nt
    buffer_load_dwordx4 v[76:79], v25, s[12:15], s60 offen offset:1024 nt
    s_add_u32 s60, s52, 49152
    buffer_load_dwordx4 v[80:83], v25, s[12:15], s60 offen offset:0 nt
    buffer_load_dwordx4 v[84:87], v25, s[12:15], s60 offen offset:1024 nt
    s_add_u32 s60, s52, 57344
    buffer_load_dwordx4 v[88:91], v25, s[12:15], s60 offen offset:0 nt
    buffer_load_dwordx4 v[92:95], v25, s[12:15], s60 offen offset:1024 nt
    v_mov_b32 v32, 0
    v_mov_b32 v34, 0
    v_mov_b32 v36, 0
    v_mov_b32 v38, 0
    v_mov_b32 v40, 0
    v_mov_b32 v42, 0
    v_mov_b32 v44, 0
    v_mov_b32 v46, 0
    v_mov_b64 v[48:49], 0
    v_mov_b64 v[50:51], 0
    v_mov_b64 v[52:53], 0
    v_mov_b64 v[54:55], 0
    v_mov_b64 v[56:57], 0
    v_mov_b64 v[58:59], 0
    v_mov_b64 v[60:61], 0
    v_mov_b64 v[62:63], 0
    v_mov_b32 v13, 0
    ds_write_b128 v25, v[48:51] offset:2048
    v_lshrrev_b32 v28, 5, v25
    v_lshlrev_b32 v28, 17, v28
    v_lshl_add_u32 v28, v10, 7, v28
    s_lshl_b32 s60, s4, 8
    v_add_u32 v28, s60, v28
    s_lshl_b32 s60, s4, 7
    s_add_u32 s60, s60, 65536
    v_writelane_b32 v28, s60, 12
    s_mov_b64 exec, 0x1fff
    s_waitcnt lgkmcnt(0)
    s_barrier
    buffer_load_dword v29, v28, s[48:51], 0 offen sc1
    s_mov_b64 exec, s[64:65]
SWAPS:
    s_waitcnt vmcnt(16)
SWAPS_Q:
    v_mov_b32 v4, v128
    v_mov_b32 v5, v129
    v_mov_b32 v6, v130
    v_mov_b32 v7, v131
    v_mov_b32_dpp v128, v132 row_ror:8 row_mask:0xf bank_mask:0xc
    v_mov_b32_dpp v129, v133 row_ror:8 row_mask:0xf bank_mask:0xc
    v_mov_b32_dpp v130, v134 row_ror:8 row_mask:0xf bank_mask:0xc
    v_mov_b32_dpp v131, v135 row_ror:8 row_mask:0xf bank_mask:0xc
    v_mov_b32_dpp v132, v4 row_ror:8 row_mask:0xf bank_mask:0x3
    v_mov_b32_dpp v133, v5 row_ror:8 row_mask:0xf bank_mask:0x3
    v_mov_b32_dpp v134, v6 row_ror:8 row_mask:0xf bank_mask:0x3
    v_mov_b32_dpp v135, v7 row_ror:8 row_mask:0xf bank_mask:0x3
    v_mov_b32 v4, v136
    v_mov_b32 v5, v137
    v_mov_b32 v6, v138
    v_mov_b32 v7, v139
    v_mov_b32_dpp v136, v140 row_ror:8 row_mask:0xf bank_mask:0xc
    v_mov_b32_dpp v137, v141 row_ror:8 row_mask:0xf bank_mask:0xc
    v_mov_b32_dpp v138, v142 row_ror:8 row_mask:0xf bank_mask:0xc
    v_mov_b32_dpp v139, v143 row_ror:8 row_mask:0xf bank_mask:0xc
    v_mov_b32_dpp v140, v4 row_ror:8 row_mask:0xf bank_mask:0x3
    v_mov_b32_dpp v141, v5 row_ror:8 row_mask:0xf bank_mask:0x3
    v_mov_b32_dpp v142, v6 row_ror:8 row_mask:0xf bank_mask:0x3
    v_mov_b32_dpp v143, v7 row_ror:8 row_mask:0xf bank_mask:0x3
    v_mov_b32 v4, v144
    v_mov_b32 v5, v145
    v_mov_b32 v6, v146
    v_mov_b32 v7, v147
    v_mov_b32_dpp v144, v148 row_ror:8 row_mask:0xf bank_mask:0xc
    v_mov_b32_dpp v145, v149 row_ror:8 row_mask:0xf bank_mask:0xc
    v_mov_b32_dpp v146, v150 row_ror:8 row_mask:0xf bank_mask:0xc
    v_mov_b32_dpp v147, v151 row_ror:8 row_mask:0xf bank_mask:0xc
    v_mov_b32_dpp v148, v4 row_ror:8 row_mask:0xf bank_mask:0x3
    v_mov_b32_dpp v149, v5 row_ror:8 row_mask:0xf bank_mask:0x3
    v_mov_b32_dpp v150, v6 row_ror:8 row_mask:0xf bank_mask:0x3
    v_mov_b32_dpp v151, v7 row_ror:8 row_mask:0xf bank_mask:0x3
    v_mov_b32 v4, v152
    v_mov_b32 v5, v153
    v_mov_b32 v6, v154
    v_mov_b32 v7, v155
    v_mov_b32_dpp v152, v156 row_ror:8 row_mask:0xf bank_mask:0xc
    v_mov_b32_dpp v153, v157 row_ror:8 row_mask:0xf bank_mask:0xc
    v_mov_b32_dpp v154, v158 row_ror:8 row_mask:0xf bank_mask:0xc
    v_mov_b32_dpp v155, v159 row_ror:8 row_mask:0xf bank_mask:0xc
    v_mov_b32_dpp v156, v4 row_ror:8 row_mask:0xf bank_mask:0x3
    v_mov_b32_dpp v157, v5 row_ror:8 row_mask:0xf bank_mask:0x3
    v_mov_b32_dpp v158, v6 row_ror:8 row_mask:0xf bank_mask:0x3
    v_mov_b32_dpp v159, v7 row_ror:8 row_mask:0xf bank_mask:0x3
    v_mov_b32 v4, v160
    v_mov_b32 v5, v161
    v_mov_b32 v6, v162
    v_mov_b32 v7, v163
    v_mov_b32_dpp v160, v164 row_ror:8 row_mask:0xf bank_mask:0xc
    v_mov_b32_dpp v161, v165 row_ror:8 row_mask:0xf bank_mask:0xc
    v_mov_b32_dpp v162, v166 row_ror:8 row_mask:0xf bank_mask:0xc
    v_mov_b32_dpp v163, v167 row_ror:8 row_mask:0xf bank_mask:0xc
    v_mov_b32_dpp v164, v4 row_ror:8 row_mask:0xf bank_mask:0x3
    v_mov_b32_dpp v165, v5 row_ror:8 row_mask:0xf bank_mask:0x3
    v_mov_b32_dpp v166, v6 row_ror:8 row_mask:0xf bank_mask:0x3
    v_mov_b32_dpp v167, v7 row_ror:8 row_mask:0xf bank_mask:0x3
    v_mov_b32 v4, v168
    v_mov_b32 v5, v169
    v_mov_b32 v6, v170
    v_mov_b32 v7, v171
    v_mov_b32_dpp v168, v172 row_ror:8 row_mask:0xf bank_mask:0xc
    v_mov_b32_dpp v169, v173 row_ror:8 row_mask:0xf bank_mask:0xc
    v_mov_b32_dpp v170, v174 row_ror:8 row_mask:0xf bank_mask:0xc
    v_mov_b32_dpp v171, v175 row_ror:8 row_mask:0xf bank_mask:0xc
    v_mov_b32_dpp v172, v4 row_ror:8 row_mask:0xf bank_mask:0x3
    v_mov_b32_dpp v173, v5 row_ror:8 row_mask:0xf bank_mask:0x3
    v_mov_b32_dpp v174, v6 row_ror:8 row_mask:0xf bank_mask:0x3
    v_mov_b32_dpp v175, v7 row_ror:8 row_mask:0xf bank_mask:0x3
    v_mov_b32 v4, v176
    v_mov_b32 v5, v177
    v_mov_b32 v6, v178
    v_mov_b32 v7, v179
    v_mov_b32_dpp v176, v180 row_ror:8 row_mask:0xf bank_mask:0xc
    v_mov_b32_dpp v177, v181 row_ror:8 row_mask:0xf bank_mask:0xc
    v_mov_b32_dpp v178, v182 row_ror:8 row_mask:0xf bank_mask:0xc
    v_mov_b32_dpp v179, v183 row_ror:8 row_mask:0xf bank_mask:0xc
    v_mov_b32_dpp v180, v4 row_ror:8 row_mask:0xf bank_mask:0x3
    v_mov_b32_dpp v181, v5 row_ror:8 row_mask:0xf bank_mask:0x3
    v_mov_b32_dpp v182, v6 row_ror:8 row_mask:0xf bank_mask:0x3
    v_mov_b32_dpp v183, v7 row_ror:8 row_mask:0xf bank_mask:0x3
    v_mov_b32 v4, v184
    v_mov_b32 v5, v185
    v_mov_b32 v6, v186
    v_mov_b32 v7, v187
    v_mov_b32_dpp v184, v188 row_ror:8 row_mask:0xf bank_mask:0xc
    v_mov_b32_dpp v185, v189 row_ror:8 row_mask:0xf bank_mask:0xc
    v_mov_b32_dpp v186, v190 row_ror:8 row_mask:0xf bank_mask:0xc
    v_mov_b32_dpp v187, v191 row_ror:8 row_mask:0xf bank_mask:0xc
    v_mov_b32_dpp v188, v4 row_ror:8 row_mask:0xf bank_mask:0x3
    v_mov_b32_dpp v189, v5 row_ror:8 row_mask:0xf bank_mask:0x3
    v_mov_b32_dpp v190, v6 row_ror:8 row_mask:0xf bank_mask:0x3
    v_mov_b32_dpp v191, v7 row_ror:8 row_mask:0xf bank_mask:0x3
    s_cmp_gt_u32 s3, 3
    s_cbranch_scc1 ATT_NB
    s_cmp_eq_u32 s3, 3
    s_cbranch_scc1 Q_VT
    s_waitcnt vmcnt(12)
    v_permlane32_swap_b32 v196, v212
    v_permlane32_swap_b32 v197, v213
    v_permlane32_swap_b32 v198, v214
    v_permlane32_swap_b32 v199, v215
    v_permlane32_swap_b32 v204, v220
    v_permlane32_swap_b32 v205, v221
    v_permlane32_swap_b32 v206, v222
    v_permlane32_swap_b32 v207, v223
    v_perm_b32 v192, v204, v196, s62
    v_perm_b32 v200, v204, v196, s63
    v_perm_b32 v193, v220, v212, s62
    v_perm_b32 v201, v220, v212, s63
    v_perm_b32 v208, v205, v197, s62
    v_perm_b32 v216, v205, v197, s63
    v_perm_b32 v209, v221, v213, s62
    v_perm_b32 v217, v221, v213, s63
    v_perm_b32 v224, v206, v198, s62
    v_perm_b32 v232, v206, v198, s63
    v_perm_b32 v225, v222, v214, s62
    v_perm_b32 v233, v222, v214, s63
    v_perm_b32 v240, v207, v199, s62
    v_perm_b32 v248, v207, v199, s63
    v_perm_b32 v241, v223, v215, s62
    v_perm_b32 v249, v223, v215, s63
    s_waitcnt vmcnt(8)
    v_permlane32_swap_b32 v228, v244
    v_permlane32_swap_b32 v229, v245
    v_permlane32_swap_b32 v230, v246
    v_permlane32_swap_b32 v231, v247
    v_permlane32_swap_b32 v236, v252
    v_permlane32_swap_b32 v237, v253
    v_permlane32_swap_b32 v238, v254
    v_permlane32_swap_b32 v239, v255
    v_perm_b32 v194, v236, v228, s62
    v_perm_b32 v202, v236, v228, s63
    v_perm_b32 v195, v252, v244, s62
    v_perm_b32 v203, v252, v244, s63
    v_perm_b32 v210, v237, v229, s62
    v_perm_b32 v218, v237, v229, s63
    v_perm_b32 v211, v253, v245, s62
    v_perm_b32 v219, v253, v245, s63
    v_perm_b32 v226, v238, v230, s62
    v_perm_b32 v234, v238, v230, s63
    v_perm_b32 v227, v254, v246, s62
    v_perm_b32 v235, v254, v246, s63
    v_perm_b32 v242, v239, v231, s62
    v_perm_b32 v250, v239, v231, s63
    v_perm_b32 v243, v255, v247, s62
    v_perm_b32 v251, v255, v247, s63
    s_waitcnt vmcnt(4)
    v_permlane32_swap_b32 v32, v40
    v_permlane32_swap_b32 v33, v41
    v_permlane32_swap_b32 v34, v42
    v_permlane32_swap_b32 v35, v43
    v_permlane32_swap_b32 v36, v44
    v_permlane32_swap_b32 v37, v45
    v_permlane32_swap_b32 v38, v46
    v_permlane32_swap_b32 v39, v47
    v_perm_b32 v196, v36, v32, s62
    v_perm_b32 v204, v36, v32, s63
    v_perm_b32 v197, v44, v40, s62
    v_perm_b32 v205, v44, v40, s63
    v_perm_b32 v212, v37, v33, s62
    v_perm_b32 v220, v37, v33, s63
    v_perm_b32 v213, v45, v41, s62
    v_perm_b32 v221, v45, v41, s63
    v_perm_b32 v228, v38, v34, s62
    v_perm_b32 v236, v38, v34, s63
    v_perm_b32 v229, v46, v42, s62
    v_perm_b32 v237, v46, v42, s63
    v_perm_b32 v244, v39, v35, s62
    v_perm_b32 v252, v39, v35, s63
    v_perm_b32 v245, v47, v43, s62
    v_perm_b32 v253, v47, v43, s63
    s_waitcnt vmcnt(0)
    v_permlane32_swap_b32 v48, v56
    v_permlane32_swap_b32 v49, v57
    v_permlane32_swap_b32 v50, v58
    v_permlane32_swap_b32 v51, v59
    v_permlane32_swap_b32 v52, v60
    v_permlane32_swap_b32 v53, v61
    v_permlane32_swap_b32 v54, v62
    v_permlane32_swap_b32 v55, v63
    v_perm_b32 v198, v52, v48, s62
    v_perm_b32 v206, v52, v48, s63
    v_perm_b32 v199, v60, v56, s62
    v_perm_b32 v207, v60, v56, s63
    v_perm_b32 v214, v53, v49, s62
    v_perm_b32 v222, v53, v49, s63
    v_perm_b32 v215, v61, v57, s62
    v_perm_b32 v223, v61, v57, s63
    v_perm_b32 v230, v54, v50, s62
    v_perm_b32 v238, v54, v50, s63
    v_perm_b32 v231, v62, v58, s62
    v_perm_b32 v239, v62, v58, s63
    v_perm_b32 v246, v55, v51, s62
    v_perm_b32 v254, v55, v51, s63
    v_perm_b32 v247, v63, v59, s62
    v_perm_b32 v255, v63, v59, s63
    s_waitcnt lgkmcnt(0)
B0A:
    s_branch PRE_DONE
PRE_A:
    s_and_b32 s7, s5, 3
    s_lshl_b32 s7, s7, 3
    s_lshr_b32 s60, s5, 2
    s_add_u32 s7, s7, s60
    s_cmp_eq_u32 s3, 0
    s_cbranch_scc1 W0_SET
    s_cmp_eq_u32 s3, 1
    s_cbranch_scc1 W1_SET
    s_cmp_eq_u32 s3, 3
    s_cbranch_scc1 PRE_Q
    v_lshl_add_u32 v3, v12, 5, v13
    v_lshlrev_b32 v3, 10, v3
    v_lshlrev_b32 v20, 3, v4
    s_lshl_b32 s60, s7, 16
    s_add_u32 s60, s60, s83
    v_add3_u32 v3, v3, v20, s60
    s_branch LD_A
W1_SET:
    v_lshlrev_b32 v3, 1, v13
    v_lshl_add_u32 v3, v12, 5, v3
    s_lshl_b32 s60, s6, 6
    v_add_u32 v3, s60, v3
    v_mul_u32_u24 v3, 2752, v3
    s_lshl_b32 s60, s7, 7
    v_lshl_add_u32 v4, v4, 3, s60
    v_add_u32 v3, v3, v4
    v_cmp_lt_u32 vcc, 2751, v4
    v_bfrev_b32 v4, 1
    s_nop 0
    v_cndmask_b32 v3, v3, v4, vcc
    s_branch LD_A
W0_SET:
    v_lshlrev_b32 v3, 3, v4
    v_lshl_add_u32 v3, v5, 13, v3
    s_lshl_b32 s60, s5, 17
    s_add_u32 s60, s60, s83
    v_add_u32 v3, s60, v3
    v_bfe_u32 v6, v1, 1, 1
    v_lshrrev_b32 v7, 2, v4
    v_lshl_add_u32 v7, v7, 1, v10
    v_lshlrev_b32 v15, 8, v7
    v_lshl_add_u32 v15, v5, 5, v15
    v_lshl_add_u32 v15, v6, 4, v15
LD_A:
    s_waitcnt lgkmcnt(0)
    s_add_u32 s60, s52, 0
    buffer_load_dwordx4 v[128:131], v30, s[8:11], s60 offen offset:0 nt
    buffer_load_dwordx4 v[136:139], v30, s[8:11], s60 offen offset:128 nt
    s_add_u32 s60, s52, 16384
    buffer_load_dwordx4 v[132:135], v30, s[8:11], s60 offen offset:0 nt
    buffer_load_dwordx4 v[140:143], v30, s[8:11], s60 offen offset:128 nt
    s_add_u32 s60, s52, 8192
    buffer_load_dwordx4 v[144:147], v30, s[8:11], s60 offen offset:0 nt
    buffer_load_dwordx4 v[152:155], v30, s[8:11], s60 offen offset:128 nt
    s_add_u32 s60, s52, 24576
    buffer_load_dwordx4 v[148:151], v30, s[8:11], s60 offen offset:0 nt
    buffer_load_dwordx4 v[156:159], v30, s[8:11], s60 offen offset:128 nt
    s_add_u32 s60, s52, 32768
    buffer_load_dwordx4 v[160:163], v30, s[8:11], s60 offen offset:0 nt
    buffer_load_dwordx4 v[168:171], v30, s[8:11], s60 offen offset:128 nt
    s_add_u32 s60, s52, 49152
    buffer_load_dwordx4 v[164:167], v30, s[8:11], s60 offen offset:0 nt
    buffer_load_dwordx4 v[172:175], v30, s[8:11], s60 offen offset:128 nt
    s_add_u32 s60, s52, 40960
    buffer_load_dwordx4 v[176:179], v30, s[8:11], s60 offen offset:0 nt
    buffer_load_dwordx4 v[184:187], v30, s[8:11], s60 offen offset:128 nt
    s_add_u32 s60, s52, 57344
    buffer_load_dwordx4 v[180:183], v30, s[8:11], s60 offen offset:0 nt
    buffer_load_dwordx4 v[188:191], v30, s[8:11], s60 offen offset:128 nt
    s_add_u32 s60, s52, 0
    buffer_load_dwordx4 v[196:199], v25, s[12:15], s60 offen offset:0 nt
    buffer_load_dwordx4 v[204:207], v25, s[12:15], s60 offen offset:1024 nt
    s_add_u32 s60, s52, 8192
    buffer_load_dwordx4 v[212:215], v25, s[12:15], s60 offen offset:0 nt
    buffer_load_dwordx4 v[220:223], v25, s[12:15], s60 offen offset:1024 nt
    s_add_u32 s60, s52, 16384
    buffer_load_dwordx4 v[228:231], v25, s[12:15], s60 offen offset:0 nt
    buffer_load_dwordx4 v[236:239], v25, s[12:15], s60 offen offset:1024 nt
    s_add_u32 s60, s52, 24576
    buffer_load_dwordx4 v[244:247], v25, s[12:15], s60 offen offset:0 nt
    buffer_load_dwordx4 v[252:255], v25, s[12:15], s60 offen offset:1024 nt
    s_add_u32 s60, s52, 32768
    buffer_load_dwordx4 v[32:35], v25, s[12:15], s60 offen offset:0 nt
    buffer_load_dwordx4 v[36:39], v25, s[12:15], s60 offen offset:1024 nt
    s_add_u32 s60, s52, 40960
    buffer_load_dwordx4 v[40:43], v25, s[12:15], s60 offen offset:0 nt
    buffer_load_dwordx4 v[44:47], v25, s[12:15], s60 offen offset:1024 nt
    s_add_u32 s60, s52, 49152
    buffer_load_dwordx4 v[48:51], v25, s[12:15], s60 offen offset:0 nt
    buffer_load_dwordx4 v[52:55], v25, s[12:15], s60 offen offset:1024 nt
    s_add_u32 s60, s52, 57344
    buffer_load_dwordx4 v[56:59], v25, s[12:15], s60 offen offset:0 nt
    buffer_load_dwordx4 v[60:63], v25, s[12:15], s60 offen offset:1024 nt
    s_branch SWAPS
PRE_Q:
    v_mov_b64 v[10:11], 0
    v_and_b32 v14, 0x70, v25
    s_lshl_b32 s60, s5, 3
    s_cmp_eq_u32 s6, 0
    s_cbranch_scc0 NOFLAG
    s_mov_b64 exec, s[68:69]
    s_waitcnt vmcnt(36)
    buffer_store_dword v20, v25, s[44:47], s60 offen sc1
    s_mov_b64 exec, s[64:65]
NOFLAG:
    s_waitcnt vmcnt(34)
    ds_write_b32 v25, v8 offset:4608
    v_dot2c_f32_bf16 v10, v192, v20
    v_dot2c_f32_bf16 v11, v192, v192
    s_nop 1
    v_dot2c_f32_bf16 v10, v193, v20
    v_dot2c_f32_bf16 v11, v193, v193
    s_nop 1
    v_dot2c_f32_bf16 v10, v194, v20
    v_dot2c_f32_bf16 v11, v194, v194
    s_nop 1
    v_dot2c_f32_bf16 v10, v195, v20
    v_dot2c_f32_bf16 v11, v195, v195
    s_nop 1
    v_add_f32_dpp v10, v10, v10 row_ror:8 row_mask:0xf bank_mask:0xf
    v_add_f32_dpp v11, v11, v11 row_ror:8 row_mask:0xf bank_mask:0xf
    s_nop 0
    v_add_f32_dpp v10, v10, v10 row_ror:4 row_mask:0xf bank_mask:0xf
    v_add_f32_dpp v11, v11, v11 row_ror:4 row_mask:0xf bank_mask:0xf
    s_nop 0
    v_add_f32_dpp v10, v10, v10 row_ror:2 row_mask:0xf bank_mask:0xf
    v_add_f32_dpp v11, v11, v11 row_ror:2 row_mask:0xf bank_mask:0xf
    s_nop 0
    v_add_f32_dpp v10, v10, v10 row_ror:1 row_mask:0xf bank_mask:0xf
    v_add_f32_dpp v11, v11, v11 row_ror:1 row_mask:0xf bank_mask:0xf
    s_nop 0
    v_add_f32_dpp v10, v10, v10 row_bcast:15 row_mask:0xa bank_mask:0xf
    v_add_f32_dpp v11, v11, v11 row_bcast:15 row_mask:0xa bank_mask:0xf
    s_nop 0
    v_add_f32_dpp v10, v10, v10 row_bcast:31 row_mask:0xc bank_mask:0xf
    v_add_f32_dpp v11, v11, v11 row_bcast:31 row_mask:0xc bank_mask:0xf
    v_mul_f32 v10, 0x3b000000, v10
    v_mul_f32 v11, 0x3b000000, v11
    s_mov_b32 s61, 0x3727c5ac
    v_fma_f32 v11, -v10, v10, v11
    v_add_f32_e64 v11, |v11|, s61
    v_rsq_f32 v11, v11
    v_readlane_b32 s60, v10, 63
    v_lshlrev_b32 v9, 16, v8
    v_readlane_b32 s61, v11, 63
    v_and_b32 v8, 0xffff0000, v8
    v_subrev_f32 v9, s60, v9
    v_subrev_f32 v8, s60, v8
    v_mul_f32 v9, s61, v9
    v_mul_f32 v8, s61, v8
    v_cvt_pk_bf16_f32 v8, v9, v8
    s_nop 1
    v_mov_b32_dpp v9, v8 row_shl:2 row_mask:0xf bank_mask:0xf
    v_mov_b32_dpp v10, v8 row_shl:4 row_mask:0xf bank_mask:0xf
    v_mov_b32_dpp v11, v8 row_shl:6 row_mask:0xf bank_mask:0xf
    s_waitcnt vmcnt(30)
    v_perm_b32 v64, v76, v68, s62
    v_perm_b32 v72, v76, v68, s63
    v_perm_b32 v65, v92, v84, s62
    v_perm_b32 v73, v92, v84, s63
    v_perm_b32 v80, v77, v69, s62
    v_perm_b32 v88, v77, v69, s63
    v_perm_b32 v81, v93, v85, s62
    v_perm_b32 v89, v93, v85, s63
    v_perm_b32 v96, v78, v70, s62
    v_perm_b32 v104, v78, v70, s63
    v_perm_b32 v97, v94, v86, s62
    v_perm_b32 v105, v94, v86, s63
    v_perm_b32 v112, v79, v71, s62
    v_perm_b32 v120, v79, v71, s63
    v_perm_b32 v113, v95, v87, s62
    v_perm_b32 v121, v95, v87, s63
    s_waitcnt vmcnt(26)
    v_perm_b32 v66, v108, v100, s62
    v_perm_b32 v74, v108, v100, s63
    v_perm_b32 v67, v124, v116, s62
    v_perm_b32 v75, v124, v116, s63
    v_perm_b32 v82, v109, v101, s62
    v_perm_b32 v90, v109, v101, s63
    v_perm_b32 v83, v125, v117, s62
    v_perm_b32 v91, v125, v117, s63
    v_perm_b32 v98, v110, v102, s62
    v_perm_b32 v106, v110, v102, s63
    v_perm_b32 v99, v126, v118, s62
    v_perm_b32 v107, v126, v118, s63
    v_perm_b32 v114, v111, v103, s62
    v_perm_b32 v122, v111, v103, s63
    v_perm_b32 v115, v127, v119, s62
    v_perm_b32 v123, v127, v119, s63
    s_waitcnt vmcnt(22)
    v_perm_b32 v68, v36, v32, s62
    v_perm_b32 v76, v36, v32, s63
    v_perm_b32 v69, v44, v40, s62
    v_perm_b32 v77, v44, v40, s63
    v_perm_b32 v84, v37, v33, s62
    v_perm_b32 v92, v37, v33, s63
    v_perm_b32 v85, v45, v41, s62
    v_perm_b32 v93, v45, v41, s63
    v_perm_b32 v100, v38, v34, s62
    v_perm_b32 v108, v38, v34, s63
    v_perm_b32 v101, v46, v42, s62
    v_perm_b32 v109, v46, v42, s63
    v_perm_b32 v116, v39, v35, s62
    v_perm_b32 v124, v39, v35, s63
    v_perm_b32 v117, v47, v43, s62
    v_perm_b32 v125, v47, v43, s63
    s_waitcnt vmcnt(18)
    v_perm_b32 v70, v52, v48, s62
    v_perm_b32 v78, v52, v48, s63
    v_perm_b32 v71, v60, v56, s62
    v_perm_b32 v79, v60, v56, s63
    v_perm_b32 v86, v53, v49, s62
    v_perm_b32 v94, v53, v49, s63
    v_perm_b32 v87, v61, v57, s62
    v_perm_b32 v95, v61, v57, s63
    v_perm_b32 v102, v54, v50, s62
    v_perm_b32 v110, v54, v50, s63
    v_perm_b32 v103, v62, v58, s62
    v_perm_b32 v111, v62, v58, s63
    v_perm_b32 v118, v55, v51, s62
    v_perm_b32 v126, v55, v51, s63
    v_perm_b32 v119, v63, v59, s62
    v_perm_b32 v127, v63, v59, s63
    v_mov_b64 v[32:33], 0
    v_mov_b64 v[36:37], 0
    v_mov_b64 v[40:41], 0
    v_mov_b64 v[44:45], 0
    v_mov_b64 v[48:49], 0
    v_mov_b64 v[52:53], 0
    v_mov_b64 v[56:57], 0
    v_mov_b64 v[60:61], 0
    v_smfmac_f32_16x16x64_bf16 v[32:35], v[20:23], v[64:71], v1
    v_smfmac_f32_16x16x64_bf16 v[36:39], v[20:23], v[72:79], v1
    v_smfmac_f32_16x16x64_bf16 v[40:43], v[20:23], v[80:87], v1
    v_smfmac_f32_16x16x64_bf16 v[44:47], v[20:23], v[88:95], v1
    v_smfmac_f32_16x16x64_bf16 v[48:51], v[20:23], v[96:103], v1
    v_add_f32 v32, v32, v33
    v_smfmac_f32_16x16x64_bf16 v[52:55], v[20:23], v[104:111], v1
    v_add_f32 v36, v36, v37
    v_smfmac_f32_16x16x64_bf16 v[56:59], v[20:23], v[112:119], v1
    v_add_f32 v40, v40, v41
    v_smfmac_f32_16x16x64_bf16 v[60:63], v[20:23], v[120:127], v1
    v_add_f32 v44, v44, v45
    v_add_f32 v48, v48, v49
    v_cvt_pk_bf16_f32 v32, v32, v36
    v_add_f32 v52, v52, v53
    v_cvt_pk_bf16_f32 v33, v40, v44
    v_add_f32 v56, v56, v57
    v_cvt_pk_bf16_f32 v34, v48, v52
    s_mov_b64 exec, s[66:67]
    v_add_f32 v60, v60, v61
    v_cvt_pk_bf16_f32 v35, v56, v60
    s_add_u32 s60, s75, 393216
    buffer_store_dwordx4 v[32:35], v25, s[48:51], s60 offen sc1
    s_mov_b64 exec, s[64:65]
    v_mov_b64 v[36:37], 0
    v_mov_b64 v[40:41], 0
    v_mov_b64 v[44:45], 0
    v_mov_b64 v[48:49], 0
    v_mov_b64 v[52:53], 0
    v_mov_b64 v[56:57], 0
    v_mov_b64 v[60:61], 0
    v_mov_b64 v[32:33], 0
    s_nop 1
    v_smfmac_f32_16x16x64_bf16 v[32:35], v[8:11], v[64:71], v1
    v_smfmac_f32_16x16x64_bf16 v[36:39], v[8:11], v[72:79], v1
    v_smfmac_f32_16x16x64_bf16 v[40:43], v[8:11], v[80:87], v1
    v_smfmac_f32_16x16x64_bf16 v[44:47], v[8:11], v[88:95], v1
    v_smfmac_f32_16x16x64_bf16 v[48:51], v[8:11], v[96:103], v1
    v_add_f32 v32, v32, v33
    v_smfmac_f32_16x16x64_bf16 v[52:55], v[8:11], v[104:111], v1
    v_add_f32 v36, v36, v37
    v_smfmac_f32_16x16x64_bf16 v[56:59], v[8:11], v[112:119], v1
    v_add_f32 v40, v40, v41
    v_smfmac_f32_16x16x64_bf16 v[60:63], v[8:11], v[120:127], v1
    v_add_f32 v44, v44, v45
    v_add_f32 v48, v48, v49
    v_cvt_pk_bf16_f32 v32, v32, v36
    v_add_f32 v52, v52, v53
    v_cvt_pk_bf16_f32 v33, v40, v44
    v_add_f32 v56, v56, v57
    v_cvt_pk_bf16_f32 v34, v48, v52
    s_mov_b64 exec, s[66:67]
    v_add_f32 v60, v60, v61
    v_cvt_pk_bf16_f32 v35, v56, v60
    s_mov_b64 exec, s[64:65]
    buffer_load_dword v13, v15, s[44:47], 0 offen sc1
    buffer_load_dwordx4 v[196:199], v25, s[12:15], s52 offen offset:0 nt
    buffer_load_dwordx4 v[204:207], v25, s[12:15], s52 offen offset:1024 nt
    buffer_load_dwordx4 v[212:215], v25, s[12:15], s53 offen offset:0 nt
    buffer_load_dwordx4 v[220:223], v25, s[12:15], s53 offen offset:1024 nt
    buffer_load_dwordx4 v[228:231], v25, s[12:15], s54 offen offset:0 nt
    buffer_load_dwordx4 v[236:239], v25, s[12:15], s54 offen offset:1024 nt
    buffer_load_dwordx4 v[244:247], v25, s[12:15], s55 offen offset:0 nt
    buffer_load_dwordx4 v[252:255], v25, s[12:15], s55 offen offset:1024 nt
    s_getreg_b32 s54, hwreg(HW_REG_XCC_ID)
    s_and_b32 s54, s54, 15
    v_mov_b32 v12, s54
    s_add_u32 s52, s77, 262144
    s_lshl_b32 s53, s5, 7
    s_add_u32 s53, s53, 851968
    s_lshl_b32 s55, s6, 4
    s_add_u32 s55, s55, s53
    s_add_u32 s61, s75, 262144
    s_waitcnt vmcnt(8)
FL_chk:
    v_readlane_b32 s60, v13, s5
    s_cmp_eq_u32 s60, 0
    s_cbranch_scc1 FL_retry
FL_ok:
    s_mov_b64 exec, s[66:67]
    buffer_store_dwordx4 v[32:35], v25, s[48:51], s61 offen sc1
    s_mov_b64 exec, s[68:69]
    buffer_store_dword v12, v25, s[48:51], s55 offen sc1
    s_mov_b64 exec, s[64:65]
    buffer_load_dwordx4 v[32:35], v25, s[12:15], s56 offen offset:0 nt
    buffer_load_dwordx4 v[36:39], v25, s[12:15], s56 offen offset:1024 nt
    buffer_load_dwordx4 v[40:43], v25, s[12:15], s57 offen offset:0 nt
    buffer_load_dwordx4 v[44:47], v25, s[12:15], s57 offen offset:1024 nt
    buffer_load_dwordx4 v[48:51], v25, s[12:15], s58 offen offset:0 nt
    buffer_load_dwordx4 v[52:55], v25, s[12:15], s58 offen offset:1024 nt
    buffer_load_dwordx4 v[56:59], v25, s[12:15], s59 offen offset:0 nt
    buffer_load_dwordx4 v[60:63], v25, s[12:15], s59 offen offset:1024 nt
    s_branch SWAPS_Q
FL_retry:
    s_sub_u32 s72, s72, 1
    s_cbranch_scc1 FL_out
    buffer_load_dword v13, v15, s[44:47], 0 offen sc1
    s_waitcnt vmcnt(0)
    s_branch FL_chk
FL_out:
    s_mov_b32 s72, 0
    s_branch FL_ok
GQ_retry:
    s_sub_u32 s72, s72, 1
    s_cbranch_scc1 GQ_out
    buffer_load_dword v13, v15, s[44:47], 0 offen sc1
    buffer_load_dword v12, v14, s[48:51], s53 offen sc1
    buffer_load_dwordx4 v[4:7], v25, s[48:51], s52 offen sc1
    buffer_load_dwordx4 v[8:11], v25, s[48:51], s52 offen offset:1024 sc1
    s_branch GQ_chk
GQ_out:
    s_mov_b32 s72, 0
    s_branch GQ_ok
Q_VT:
    s_waitcnt vmcnt(14)
    v_permlane32_swap_b32 v196, v212
    v_permlane32_swap_b32 v197, v213
    v_permlane32_swap_b32 v198, v214
    v_permlane32_swap_b32 v199, v215
    v_permlane32_swap_b32 v204, v220
    v_permlane32_swap_b32 v205, v221
    v_permlane32_swap_b32 v206, v222
    v_permlane32_swap_b32 v207, v223
    v_perm_b32 v192, v204, v196, s62
    v_perm_b32 v200, v204, v196, s63
    v_perm_b32 v193, v220, v212, s62
    v_perm_b32 v201, v220, v212, s63
    v_perm_b32 v208, v205, v197, s62
    v_perm_b32 v216, v205, v197, s63
    v_perm_b32 v209, v221, v213, s62
    v_perm_b32 v217, v221, v213, s63
    v_perm_b32 v224, v206, v198, s62
    v_perm_b32 v232, v206, v198, s63
    v_perm_b32 v225, v222, v214, s62
    v_perm_b32 v233, v222, v214, s63
    v_perm_b32 v240, v207, v199, s62
    v_perm_b32 v248, v207, v199, s63
    v_perm_b32 v241, v223, v215, s62
    v_perm_b32 v249, v223, v215, s63
    s_waitcnt vmcnt(10)
    v_permlane32_swap_b32 v228, v244
    v_permlane32_swap_b32 v229, v245
    v_permlane32_swap_b32 v230, v246
    v_permlane32_swap_b32 v231, v247
    v_permlane32_swap_b32 v236, v252
    v_permlane32_swap_b32 v237, v253
    v_permlane32_swap_b32 v238, v254
    v_permlane32_swap_b32 v239, v255
    v_perm_b32 v194, v236, v228, s62
    v_perm_b32 v202, v236, v228, s63
    v_perm_b32 v195, v252, v244, s62
    v_perm_b32 v203, v252, v244, s63
    v_perm_b32 v210, v237, v229, s62
    v_perm_b32 v218, v237, v229, s63
    v_perm_b32 v211, v253, v245, s62
    v_perm_b32 v219, v253, v245, s63
    v_perm_b32 v226, v238, v230, s62
    v_perm_b32 v234, v238, v230, s63
    v_perm_b32 v227, v254, v246, s62
    v_perm_b32 v235, v254, v246, s63
    v_perm_b32 v242, v239, v231, s62
    v_perm_b32 v250, v239, v231, s63
    v_perm_b32 v243, v255, v247, s62
    v_perm_b32 v251, v255, v247, s63
    buffer_load_dword v13, v15, s[44:47], 0 offen sc1
    buffer_load_dword v12, v14, s[48:51], s53 offen sc1
    buffer_load_dwordx4 v[4:7], v25, s[48:51], s52 offen sc1
    buffer_load_dwordx4 v[8:11], v25, s[48:51], s52 offen offset:1024 sc1
    s_waitcnt vmcnt(8)
    v_permlane32_swap_b32 v32, v40
    v_permlane32_swap_b32 v33, v41
    v_permlane32_swap_b32 v34, v42
    v_permlane32_swap_b32 v35, v43
    v_permlane32_swap_b32 v36, v44
    v_permlane32_swap_b32 v37, v45
    v_permlane32_swap_b32 v38, v46
    v_permlane32_swap_b32 v39, v47
    v_perm_b32 v196, v36, v32, s62
    v_perm_b32 v204, v36, v32, s63
    v_perm_b32 v197, v44, v40, s62
    v_perm_b32 v205, v44, v40, s63
    v_perm_b32 v212, v37, v33, s62
    v_perm_b32 v220, v37, v33, s63
    v_perm_b32 v213, v45, v41, s62
    v_perm_b32 v221, v45, v41, s63
    v_perm_b32 v228, v38, v34, s62
    v_perm_b32 v236, v38, v34, s63
    v_perm_b32 v229, v46, v42, s62
    v_perm_b32 v237, v46, v42, s63
    v_perm_b32 v244, v39, v35, s62
    v_perm_b32 v252, v39, v35, s63
    v_perm_b32 v245, v47, v43, s62
    v_perm_b32 v253, v47, v43, s63
    s_waitcnt vmcnt(4)
    v_permlane32_swap_b32 v48, v56
    v_permlane32_swap_b32 v49, v57
    v_permlane32_swap_b32 v50, v58
    v_permlane32_swap_b32 v51, v59
    v_permlane32_swap_b32 v52, v60
    v_permlane32_swap_b32 v53, v61
    v_permlane32_swap_b32 v54, v62
    v_permlane32_swap_b32 v55, v63
    v_perm_b32 v198, v52, v48, s62
    v_perm_b32 v206, v52, v48, s63
    v_perm_b32 v199, v60, v56, s62
    v_perm_b32 v207, v60, v56, s63
    v_perm_b32 v214, v53, v49, s62
    v_perm_b32 v222, v53, v49, s63
    v_perm_b32 v215, v61, v57, s62
    v_perm_b32 v223, v61, v57, s63
    v_perm_b32 v230, v54, v50, s62
    v_perm_b32 v238, v54, v50, s63
    v_perm_b32 v231, v62, v58, s62
    v_perm_b32 v239, v62, v58, s63
    v_perm_b32 v246, v55, v51, s62
    v_perm_b32 v254, v55, v51, s63
    v_perm_b32 v247, v63, v59, s62
    v_perm_b32 v255, v63, v59, s63
GQ_chk:
    v_mov_b64 v[32:33], 0
    s_waitcnt vmcnt(0)
    s_nop 0
    v_smfmac_f32_16x16x64_bf16 v[32:35], v[16:19], v[4:11], v24
    v_cmp_eq_u32 s[56:57], 0, v13
    v_cmp_eq_u32 s[58:59], -1, v12
    v_cmp_ne_u32 s[60:61], s54, v12
    s_nop 4
    v_mul_f32 v32, 0x3e0293ee, v32
    v_mul_f32 v33, 0x3e0293ee, v33
    s_or_b64 s[56:57], s[56:57], s[58:59]
    v_cmp_u_f32 vcc, v32, v33
    v_cvt_pk_bf16_f32 v4, v32, v33
    s_or_b64 vcc, vcc, s[56:57]
    s_cbranch_scc1 GQ_retry
GQ_ok:
    ds_write_b32 v27, v4 offset:4352
    s_cmp_eq_u64 s[60:61], 0
    s_cselect_b32 s73, 1, 0
    v_mov_b32 v5, 4160
    v_mov_b32 v6, s73
    ds_write_b32 v5, v6
PRE_DONE:
ATT:
    v_mov_b32 v32, 0
    v_mov_b32 v34, 0
    v_mov_b32 v36, 0
    v_mov_b32 v38, 0
    v_mov_b32 v40, 0
    v_mov_b32 v42, 0
    v_mov_b32 v44, 0
    v_mov_b32 v46, 0
    v_mov_b64 v[48:49], 0
    v_mov_b64 v[50:51], 0
    v_mov_b64 v[52:53], 0
    v_mov_b64 v[54:55], 0
    v_mov_b64 v[56:57], 0
    v_mov_b64 v[58:59], 0
    v_mov_b64 v[60:61], 0
    v_mov_b64 v[62:63], 0
    v_mov_b32 v13, 0
ATT_Z:
    s_waitcnt lgkmcnt(0)
    s_barrier
ATT_NB:
    ds_read_b128 v[4:7], v0
    ds_read_b128 v[8:11], v0 offset:128
    s_cmp_eq_u32 s81, 0
    s_cselect_b32 s60, 0x42000000, -1.0
    s_waitcnt lgkmcnt(1)
    v_smfmac_f32_16x16x64_bf16 v[48:51], v[4:7], v[128:135], v1
    v_smfmac_f32_16x16x64_bf16 v[52:55], v[4:7], v[144:151], v1
    s_waitcnt lgkmcnt(0)
    v_smfmac_f32_16x16x64_bf16 v[48:51], v[8:11], v[136:143], v1
    v_smfmac_f32_16x16x64_bf16 v[52:55], v[8:11], v[152:159], v1
    v_smfmac_f32_16x16x64_bf16 v[56:59], v[4:7], v[160:167], v1
    v_smfmac_f32_16x16x64_bf16 v[60:63], v[4:7], v[176:183], v1
    v_add_f32 v12, v49, v51
    v_smfmac_f32_16x16x64_bf16 v[56:59], v[8:11], v[168:175], v1
    v_add_f32_dpp v12, v53, v55 quad_perm:[0,1,2,3] row_mask:0x2 bank_mask:0xf
    v_smfmac_f32_16x16x64_bf16 v[60:63], v[8:11], v[184:191], v1
    s_nop 3
    v_add_f32_dpp v12, v57, v59 quad_perm:[0,1,2,3] row_mask:0x4 bank_mask:0xf
    s_nop 2
    v_add_f32_dpp v12, v61, v63 quad_perm:[0,1,2,3] row_mask:0x8 bank_mask:0xf
    v_exp_f32 v5, v12
    v_cmp_nle_f32_e64 vcc, |v12|, s60
    s_nop 0
    v_mov_b32_dpp v6, v5 row_shl:4 row_mask:0xf bank_mask:0xf
    v_cvt_pk_bf16_f32 v8, v5, v6
    v_add_f32_dpp v5, v5, v5 row_ror:8 row_mask:0xf bank_mask:0xf
    s_nop 0
    v_mov_b32_dpp v9, v8 row_shl:8 row_mask:0xf bank_mask:0xf
    v_mov_b32_dpp v10, v8 row_shl:1 row_mask:0xf bank_mask:0xf
    v_mov_b32_dpp v11, v8 row_shl:9 row_mask:0xf bank_mask:0xf
    v_add_f32_dpp v5, v5, v5 row_ror:4 row_mask:0xf bank_mask:0xf
    s_cbranch_vccnz SMAX
PV:
    v_smfmac_f32_16x16x64_bf16 v[32:35], v[8:11], v[192:199], v1
    v_add_f32_dpp v5, v5, v5 row_ror:2 row_mask:0xf bank_mask:0xf
    v_smfmac_f32_16x16x64_bf16 v[36:39], v[8:11], v[200:207], v1
    v_lshrrev_b32 v14, 5, v26
    v_add_f32_dpp v5, v5, v5 row_ror:1 row_mask:0xf bank_mask:0xf
    v_smfmac_f32_16x16x64_bf16 v[40:43], v[8:11], v[208:215], v1
    s_cmp_eq_u32 s82, 1
    v_add_f32_dpp v5, v5, v5 row_bcast:15 row_mask:0xa bank_mask:0xf
    v_smfmac_f32_16x16x64_bf16 v[44:47], v[8:11], v[216:223], v1
    v_add_f32 v32, v32, v34
    v_add_f32_dpp v5, v5, v5 row_bcast:31 row_mask:0xc bank_mask:0xf
    v_smfmac_f32_16x16x64_bf16 v[48:51], v[8:11], v[224:231], v1
    v_add_f32 v36, v36, v38
    v_smfmac_f32_16x16x64_bf16 v[52:55], v[8:11], v[232:239], v1
    v_add_f32 v40, v40, v42
    v_cvt_pk_bf16_f32 v32, v32, v36
    v_smfmac_f32_16x16x64_bf16 v[56:59], v[8:11], v[240:247], v1
    v_add_f32 v44, v44, v46
    v_smfmac_f32_16x16x64_bf16 v[60:63], v[8:11], v[248:255], v1
    v_add_f32 v48, v48, v50
    v_cvt_pk_bf16_f32 v33, v40, v44
    v_add_f32 v52, v52, v54
    v_cvt_pk_bf16_f32 v34, v48, v52
    s_mov_b64 exec, s[70:71]
    ds_write2_b32 v2, v13, v5 offset1:8
    s_mov_b64 exec, s[66:67]
    v_add_f32 v56, v56, v58
    v_add_f32 v60, v60, v62
    v_cvt_pk_bf16_f32 v35, v56, v60
    ds_write_b128 v2, v[32:35]
    s_mov_b64 exec, s[64:65]
    s_cbranch_scc1 WL
B2:
    s_cmp_lg_u32 s3, 0
    s_waitcnt lgkmcnt(0)
    s_barrier
    s_cbranch_scc1 NOT0
    ds_read_b128 v[40:43], v25
    ds_read_b128 v[44:47], v25 offset:1024
    v_mov_b64 v[32:33], 0
    ds_read_b32 v4, v14 offset:4096
    ds_read_b32 v5, v14 offset:4128
    ds_read_b32 v48, v14 offset:4160
    s_waitcnt lgkmcnt(3)
    v_smfmac_f32_16x16x64_bf16 v[32:35], v[16:19], v[40:47], v24
    s_waitcnt lgkmcnt(0)
    v_cmp_neq_f32 vcc, 0, v4
    v_readfirstlane_b32 s73, v48
    s_cbranch_vccnz MERGE
MERGE_BACK:
    v_add_f32_dpp v5, v5, v5 row_ror:4 row_mask:0xf bank_mask:0xf
    s_cmp_eq_u32 s73, 1
    s_nop 0
    v_add_f32_dpp v5, v5, v5 row_ror:2 row_mask:0xf bank_mask:0xf
    v_cvt_pk_bf16_f32 v6, v32, v33
    s_cbranch_scc0 slow_1
    buffer_store_dword v6, v27, s[48:51], s75 offen
    v_add_f32_dpp v5, v5, v5 row_ror:1 row_mask:0xf bank_mask:0xf
    s_mov_b64 exec, s[68:69]
    buffer_store_dwordx2 v[4:5], off, s[48:51], s76
    s_cbranch_execnz sent_2
slow_1:
    buffer_store_dword v6, v27, s[48:51], s75 offen sc1
    v_add_f32_dpp v5, v5, v5 row_ror:1 row_mask:0xf bank_mask:0xf
    s_mov_b64 exec, s[68:69]
    buffer_store_dwordx2 v[4:5], off, s[48:51], s76 sc1
sent_2:
    s_mov_b64 exec, s[64:65]
    s_cmp_eq_u32 s82, 0
    s_cbranch_scc1 G1_again
    s_waitcnt vmcnt(30)
    v_perm_b32 v64, v82, v66, s62
    v_perm_b32 v80, v82, v66, s63
    v_perm_b32 v65, v114, v98, s62
    v_perm_b32 v81, v114, v98, s63
    v_perm_b32 v96, v83, v67, s62
    v_perm_b32 v112, v83, v67, s63
    v_perm_b32 v97, v115, v99, s62
    v_perm_b32 v113, v115, v99, s63
    s_waitcnt vmcnt(26)
    v_perm_b32 v66, v84, v68, s62
    v_perm_b32 v82, v84, v68, s63
    v_perm_b32 v67, v116, v100, s62
    v_perm_b32 v83, v116, v100, s63
    v_perm_b32 v98, v85, v69, s62
    v_perm_b32 v114, v85, v69, s63
    v_perm_b32 v99, v117, v101, s62
    v_perm_b32 v115, v117, v101, s63
    s_waitcnt vmcnt(22)
    v_perm_b32 v68, v86, v70, s62
    v_perm_b32 v84, v86, v70, s63
    v_perm_b32 v69, v118, v102, s62
    v_perm_b32 v85, v118, v102, s63
    v_perm_b32 v100, v87, v71, s62
    v_perm_b32 v116, v87, v71, s63
    v_perm_b32 v101, v119, v103, s62
    v_perm_b32 v117, v119, v103, s63
    s_waitcnt vmcnt(18)
    v_perm_b32 v70, v88, v72, s62
    v_perm_b32 v86, v88, v72, s63
    v_perm_b32 v71, v120, v104, s62
    v_perm_b32 v87, v120, v104, s63
    v_perm_b32 v102, v89, v73, s62
    v_perm_b32 v118, v89, v73, s63
    v_perm_b32 v103, v121, v105, s62
    v_perm_b32 v119, v121, v105, s63
    s_waitcnt vmcnt(14)
    v_perm_b32 v72, v90, v74, s62
    v_perm_b32 v88, v90, v74, s63
    v_perm_b32 v73, v122, v106, s62
    v_perm_b32 v89, v122, v106, s63
    v_perm_b32 v104, v91, v75, s62
    v_perm_b32 v120, v91, v75, s63
    v_perm_b32 v105, v123, v107, s62
    v_perm_b32 v121, v123, v107, s63
    s_waitcnt vmcnt(10)
    v_perm_b32 v74, v92, v76, s62
    v_perm_b32 v90, v92, v76, s63
    v_perm_b32 v75, v124, v108, s62
    v_perm_b32 v91, v124, v108, s63
    v_perm_b32 v106, v93, v77, s62
    v_perm_b32 v122, v93, v77, s63
    v_perm_b32 v107, v125, v109, s62
    v_perm_b32 v123, v125, v109, s63
    s_waitcnt vmcnt(6)
    v_perm_b32 v76, v94, v78, s62
    v_perm_b32 v92, v94, v78, s63
    v_perm_b32 v77, v126, v110, s62
    v_perm_b32 v93, v126, v110, s63
    v_perm_b32 v108, v95, v79, s62
    v_perm_b32 v124, v95, v79, s63
    v_perm_b32 v109, v127, v111, s62
    v_perm_b32 v125, v127, v111, s63
    s_waitcnt vmcnt(2)
    buffer_load_dwordx2 v[56:57], v26, s[48:51], s78 offen sc1
    buffer_load_dwordx4 v[48:51], v15, s[48:51], s77 offen sc1
    buffer_load_dwordx4 v[52:55], v15, s[48:51], s77 offen offset:128 sc1
    v_perm_b32 v78, v22, v20, s62
    v_perm_b32 v94, v22, v20, s63
    v_perm_b32 v79, v30, v28, s62
    v_perm_b32 v95, v30, v28, s63
    v_perm_b32 v110, v23, v21, s62
    v_perm_b32 v126, v23, v21, s63
    v_perm_b32 v111, v31, v29, s62
    v_perm_b32 v127, v31, v29, s63
    s_branch G1_zero
    s_branch G1_pre
G1_out:
    s_mov_b32 s72, 0
    s_waitcnt vmcnt(0)
    s_branch G1_go
G1_retry:
    s_sub_u32 s72, s72, 1
    s_cbranch_scc0 G1_again
    s_mov_b32 s72, 0
    s_branch G1_ok
G1_pre:
G1_again:
    buffer_load_dwordx2 v[56:57], v26, s[48:51], s78 offen sc1
    buffer_load_dwordx4 v[48:51], v15, s[48:51], s77 offen sc1
    buffer_load_dwordx4 v[52:55], v15, s[48:51], s77 offen offset:128 sc1
G1_zero:
    v_mov_b64 v[32:33], 0
    v_mov_b64 v[34:35], 0
    v_mov_b64 v[36:37], 0
    v_mov_b64 v[38:39], 0
    v_mov_b64 v[40:41], 0
    v_mov_b64 v[42:43], 0
    v_mov_b64 v[44:45], 0
    v_mov_b64 v[46:47], 0
    s_waitcnt vmcnt(3)
G1_loop:
    buffer_load_dwordx2 v[56:57], v26, s[48:51], s78 offen sc1
    buffer_load_dwordx4 v[48:51], v15, s[48:51], s77 offen sc1
    buffer_load_dwordx4 v[52:55], v15, s[48:51], s77 offen offset:128 sc1
    s_sub_u32 s72, s72, 1
    s_cbranch_scc1 G1_out
    s_waitcnt vmcnt(3)
    v_max3_u32 v14, v51, v55, v57
    v_cmp_eq_u32 vcc, -1, v14
    s_cbranch_vccnz G1_loop
G1_go:
    s_cmp_eq_u32 s82, 0
    s_cbranch_scc1 G1_nb
    s_barrier
    s_mov_b32 s82, 0
G1_nb:
    v_smfmac_f32_16x16x64_bf16 v[32:35], v[48:51], v[64:71], v1
    v_max_f32_dpp v14, v56, v56 row_ror:4 row_mask:0xf bank_mask:0xf
    v_smfmac_f32_16x16x64_bf16 v[40:43], v[48:51], v[96:103], v1
    v_max_f32_dpp v14, v14, v14 row_ror:2 row_mask:0xf bank_mask:0xf
    v_smfmac_f32_16x16x64_bf16 v[32:35], v[52:55], v[72:79], v1
    v_max_f32_dpp v14, v14, v14 row_ror:1 row_mask:0xf bank_mask:0xf
    v_smfmac_f32_16x16x64_bf16 v[40:43], v[52:55], v[104:111], v1
    v_sub_f32 v12, v56, v14
    v_exp_f32 v12, v12
    v_smfmac_f32_16x16x64_bf16 v[36:39], v[48:51], v[80:87], v1
    v_mul_f32 v13, v57, v12
    v_smfmac_f32_16x16x64_bf16 v[44:47], v[48:51], v[112:119], v1
    v_add_f32_dpp v13, v13, v13 row_ror:4 row_mask:0xf bank_mask:0xf
    v_smfmac_f32_16x16x64_bf16 v[36:39], v[52:55], v[88:95], v1
    v_add_f32_dpp v13, v13, v13 row_ror:2 row_mask:0xf bank_mask:0xf
    v_smfmac_f32_16x16x64_bf16 v[44:47], v[52:55], v[120:127], v1
    v_add_f32_dpp v13, v13, v13 row_ror:1 row_mask:0xf bank_mask:0xf
    v_rcp_f32 v13, v13
    v_pk_add_f32 v[32:33], v[32:33], v[34:35]
    v_mul_f32 v12, v12, v13
    v_pk_add_f32 v[40:41], v[40:41], v[42:43]
    v_pk_add_f32 v[36:37], v[36:37], v[38:39]
    v_mul_f32_dpp v32, v12, v32 row_newbcast:0 row_mask:0xf bank_mask:0xf
    v_mul_f32_dpp v40, v12, v40 row_newbcast:0 row_mask:0xf bank_mask:0xf
    v_pk_add_f32 v[44:45], v[44:45], v[46:47]
    v_fmac_f32_dpp v32, v12, v33 row_newbcast:1 row_mask:0xf bank_mask:0xf
    v_fmac_f32_dpp v40, v12, v41 row_newbcast:1 row_mask:0xf bank_mask:0xf
    v_mul_f32_dpp v36, v12, v36 row_newbcast:0 row_mask:0xf bank_mask:0xf
    v_mul_f32_dpp v44, v12, v44 row_newbcast:0 row_mask:0xf bank_mask:0xf
    v_fmac_f32_dpp v36, v12, v37 row_newbcast:1 row_mask:0xf bank_mask:0xf
    v_fmac_f32_dpp v44, v12, v45 row_newbcast:1 row_mask:0xf bank_mask:0xf
    v_permlane32_swap_b32 v32, v40
    v_add_f32 v32, v32, v40
    v_permlane32_swap_b32 v36, v44
    v_add_f32 v36, v36, v44
    s_nop 1
    v_permlane16_swap_b32 v32, v36
    v_add_f32 v33, v32, v36
    v_add_f32 v34, v32, v36
    v_cmp_u_f32 vcc, v33, v33
    s_nop 0
    v_permlane16_swap_b32 v33, v34
    v_cvt_pk_bf16_f32 v4, v33, v34
    v_cvt_pk_bf16_f32 v5, v33, v34
    s_cbranch_vccnz G1_retry
G1_ok:
    s_nop 0
    v_permlane32_swap_b32 v4, v5
    s_mov_b64 exec, s[66:67]
    buffer_store_dwordx2 v[4:5], v3, s[48:51], s79 offen sc1
    s_mov_b64 exec, s[64:65]
    s_cmp_eq_u32 s80, 0
    s_cbranch_scc1 H2_na
    s_waitcnt vmcnt(0)
H2_na:
    s_barrier
    s_waitcnt vmcnt(0)
    s_cbranch_execnz END0
ST1:
    s_cmp_eq_u32 s82, 0
    s_cbranch_scc1 ST1_B
    v_mov_b32 v4, 4160
    ds_read_b32 v4, v4
    s_waitcnt lgkmcnt(0)
    v_readfirstlane_b32 s73, v4
    ds_read_b32 v12, v25 offset:4608
    v_mov_b64 v[48:49], 0
    v_mov_b64 v[52:53], 0
    v_mov_b64 v[56:57], 0
    v_mov_b64 v[60:61], 0
    s_waitcnt lgkmcnt(0)
    v_lshlrev_b32 v14, 16, v12
    v_and_b32 v15, 0xffff0000, v12
    v_mul_f32 v14, 0.5, v14
    v_mul_f32 v15, 0.5, v15
    s_barrier
    s_branch WL1
WB1:
    v_lshrrev_b32 v3, 9, v25
    v_mul_u32_u24 v3, 392704, v3
    v_add_u32 v3, v3, v25
    s_mov_b32 s67, 0xffff
    s_waitcnt vmcnt(28)
    v_perm_b32 v64, v82, v66, s62
    v_perm_b32 v80, v82, v66, s63
    v_perm_b32 v65, v114, v98, s62
    v_perm_b32 v81, v114, v98, s63
    v_perm_b32 v96, v83, v67, s62
    v_perm_b32 v112, v83, v67, s63
    v_perm_b32 v97, v115, v99, s62
    v_perm_b32 v113, v115, v99, s63
    s_waitcnt vmcnt(24)
    v_perm_b32 v66, v84, v68, s62
    v_perm_b32 v82, v84, v68, s63
    v_perm_b32 v67, v116, v100, s62
    v_perm_b32 v83, v116, v100, s63
    v_perm_b32 v98, v85, v69, s62
    v_perm_b32 v114, v85, v69, s63
    v_perm_b32 v99, v117, v101, s62
    v_perm_b32 v115, v117, v101, s63
    s_waitcnt vmcnt(20)
    v_perm_b32 v68, v86, v70, s62
    v_perm_b32 v84, v86, v70, s63
    v_perm_b32 v69, v118, v102, s62
    v_perm_b32 v85, v118, v102, s63
    v_perm_b32 v100, v87, v71, s62
    v_perm_b32 v116, v87, v71, s63
    v_perm_b32 v101, v119, v103, s62
    v_perm_b32 v117, v119, v103, s63
    s_waitcnt vmcnt(16)
    v_perm_b32 v70, v88, v72, s62
    v_perm_b32 v86, v88, v72, s63
    v_perm_b32 v71, v120, v104, s62
    v_perm_b32 v87, v120, v104, s63
    v_perm_b32 v102, v89, v73, s62
    v_perm_b32 v118, v89, v73, s63
    v_perm_b32 v103, v121, v105, s62
    v_perm_b32 v119, v121, v105, s63
    s_waitcnt vmcnt(12)
    buffer_load_dwordx4 v[32:35], v25, s[48:51], s74 offen offset:0 sc1
    buffer_load_dwordx4 v[36:39], v25, s[48:51], s74 offen offset:1024 sc1
    buffer_load_dwordx4 v[40:43], v25, s[48:51], s74 offen offset:2048 sc1
    buffer_load_dwordx4 v[44:47], v25, s[48:51], s74 offen offset:3072 sc1
    v_perm_b32 v72, v90, v74, s62
    v_perm_b32 v88, v90, v74, s63
    v_perm_b32 v73, v122, v106, s62
    v_perm_b32 v89, v122, v106, s63
    v_perm_b32 v104, v91, v75, s62
    v_perm_b32 v120, v91, v75, s63
    v_perm_b32 v105, v123, v107, s62
    v_perm_b32 v121, v123, v107, s63
    s_waitcnt vmcnt(12)
    v_perm_b32 v74, v92, v76, s62
    v_perm_b32 v90, v92, v76, s63
    v_perm_b32 v75, v124, v108, s62
    v_perm_b32 v91, v124, v108, s63
    v_perm_b32 v106, v93, v77, s62
    v_perm_b32 v122, v93, v77, s63
    v_perm_b32 v107, v125, v109, s62
    v_perm_b32 v123, v125, v109, s63
    s_waitcnt vmcnt(8)
    v_perm_b32 v76, v94, v78, s62
    v_perm_b32 v92, v94, v78, s63
    v_perm_b32 v77, v126, v110, s62
    v_perm_b32 v93, v126, v110, s63
    v_perm_b32 v108, v95, v79, s62
    v_perm_b32 v124, v95, v79, s63
    v_perm_b32 v109, v127, v111, s62
    v_perm_b32 v125, v127, v111, s63
    s_waitcnt vmcnt(4)
    v_perm_b32 v78, v22, v20, s62
    v_perm_b32 v94, v22, v20, s63
    v_perm_b32 v79, v30, v28, s62
    v_perm_b32 v95, v30, v28, s63
    v_perm_b32 v110, v23, v21, s62
    v_perm_b32 v126, v23, v21, s63
    v_perm_b32 v111, v31, v29, s62
    v_perm_b32 v127, v31, v29, s63
    v_mov_b32 v20, 0x3f803f80
    v_mov_b32 v21, 0x3f803f80
    v_mov_b32 v22, 0x3f803f80
    v_mov_b32 v23, 0x3f803f80
    v_mov_b32 v28, 1.0
    v_mov_b32 v29, 1.0
    s_branch G2_wait
ST1_B:
    ds_read_b32 v12, v25 offset:4608
    v_mov_b64 v[48:49], 0
    v_mov_b64 v[52:53], 0
    v_mov_b64 v[56:57], 0
    v_mov_b64 v[60:61], 0
    s_waitcnt lgkmcnt(0)
    v_lshlrev_b32 v14, 16, v12
    v_and_b32 v15, 0xffff0000, v12
    v_mul_f32 v14, 0.5, v14
    v_mul_f32 v15, 0.5, v15
    s_branch G2_pre
G2_retry:
    s_sub_u32 s72, s72, 1
    s_cbranch_scc0 G2_loop
    s_mov_b32 s72, 0
    s_branch G2_ok
G2_pre:
    s_barrier
G2_loop:
    buffer_load_dwordx4 v[32:35], v25, s[48:51], s74 offen offset:0 sc1
    buffer_load_dwordx4 v[36:39], v25, s[48:51], s74 offen offset:1024 sc1
    buffer_load_dwordx4 v[40:43], v25, s[48:51], s74 offen offset:2048 sc1
    buffer_load_dwordx4 v[44:47], v25, s[48:51], s74 offen offset:3072 sc1
G2_wait:
    v_mov_b64 v[4:5], v[14:15]
    s_waitcnt vmcnt(2)
G2_chk:
    s_nop 0
    v_smfmac_f32_16x16x64_bf16 v[4:7], v[16:19], v[32:39], v24
    s_waitcnt vmcnt(0)
    v_smfmac_f32_16x16x64_bf16 v[4:7], v[16:19], v[40:47], v24
    v_mov_b64 v[32:33], 0
    v_mov_b64 v[36:37], 0
    v_mov_b64 v[40:41], 0
    v_mov_b64 v[44:45], 0
    s_nop 3
    v_add_f32_dpp v28, v4, v4 row_ror:8 row_mask:0xf bank_mask:0x3
    v_add_f32_dpp v29, v5, v5 row_ror:8 row_mask:0xf bank_mask:0x3
    v_cmp_u_f32 vcc, v28, v29
    v_cvt_pk_bf16_f32 v8, v28, v29
    s_cbranch_vccnz G2_retry
G2_ok:
    s_cmp_eq_u32 s73, 1
    v_mov_b32_dpp v9, v8 row_shl:2 row_mask:0xf bank_mask:0xf
    v_mov_b32_dpp v10, v8 row_shl:4 row_mask:0xf bank_mask:0xf
    v_mov_b32_dpp v11, v8 row_shl:6 row_mask:0xf bank_mask:0xf
    ds_write_b32 v25, v8 offset:4608
    s_nop 0
    v_mfma_f32_16x16x32_bf16 v[4:7], v[8:11], v[8:11], 0
    v_mfma_f32_16x16x32_bf16 v[12:15], v[8:11], v[20:23], 0
    v_smfmac_f32_16x16x64_bf16 v[32:35], v[8:11], v[64:71], v1
    v_smfmac_f32_16x16x64_bf16 v[36:39], v[8:11], v[72:79], v1
    v_smfmac_f32_16x16x64_bf16 v[40:43], v[8:11], v[80:87], v1
    v_add_f32_dpp v5, v5, v4 row_shl:1 row_mask:0xf bank_mask:0xf
    v_smfmac_f32_16x16x64_bf16 v[44:47], v[8:11], v[88:95], v1
    v_add_f32 v4, v12, v13
    v_smfmac_f32_16x16x64_bf16 v[48:51], v[8:11], v[96:103], v1
    v_add_f32 v32, v32, v33
    v_smfmac_f32_16x16x64_bf16 v[52:55], v[8:11], v[104:111], v1
    v_add_f32 v36, v36, v37
    v_smfmac_f32_16x16x64_bf16 v[56:59], v[8:11], v[112:119], v1
    v_add_f32 v40, v40, v41
    v_smfmac_f32_16x16x64_bf16 v[60:63], v[8:11], v[120:127], v1
    v_add_f32 v44, v44, v45
    v_add_f32 v48, v48, v49
    v_cvt_pk_bf16_f32 v32, v32, v36
    v_add_f32 v52, v52, v53
    v_cvt_pk_bf16_f32 v33, v40, v44
    v_add_f32 v56, v56, v57
    v_cvt_pk_bf16_f32 v34, v48, v52
    s_mov_b64 exec, s[66:67]
    v_add_f32 v60, v60, v61
    v_cvt_pk_bf16_f32 v35, v56, v60
    s_cbranch_scc0 slow_3
    buffer_store_dwordx4 v[32:35], v3, s[48:51], s75 offen
    s_mov_b64 exec, s[68:69]
    buffer_store_dwordx2 v[4:5], v25, s[48:51], s76 offen
    s_cbranch_execnz sent_4
slow_3:
    buffer_store_dwordx4 v[32:35], v3, s[48:51], s75 offen sc1
    s_mov_b64 exec, s[68:69]
    buffer_store_dwordx2 v[4:5], v25, s[48:51], s76 offen sc1
sent_4:
    s_mov_b64 exec, s[64:65]
    s_barrier
    s_waitcnt vmcnt(0)
    s_waitcnt lgkmcnt(0)
    s_barrier
    s_cbranch_execnz END1
ST2:
    s_cmp_eq_u32 s82, 0
    s_cbranch_scc1 ST2_B
    s_barrier
    s_barrier
    s_add_u32 s60, s77, 393216
    v_mov_b32 v48, 0
    v_mov_b32 v50, 0
    v_mov_b32 v52, 0
    v_mov_b32 v54, 0
    v_mov_b32 v56, 0
    v_mov_b32 v58, 0
    v_mov_b32 v60, 0
    v_mov_b32 v62, 0
    s_mov_b32 s61, 0x3727c5ac
    s_waitcnt vmcnt(12)
    v_perm_b32 v64, v82, v66, s62
    v_perm_b32 v80, v82, v66, s63
    v_perm_b32 v65, v114, v98, s62
    v_perm_b32 v81, v114, v98, s63
    v_perm_b32 v96, v83, v67, s62
    v_perm_b32 v112, v83, v67, s63
    v_perm_b32 v97, v115, v99, s62
    v_perm_b32 v113, v115, v99, s63
    s_waitcnt vmcnt(8)
    v_perm_b32 v66, v84, v68, s62
    v_perm_b32 v82, v84, v68, s63
    v_perm_b32 v67, v116, v100, s62
    v_perm_b32 v83, v116, v100, s63
    v_perm_b32 v98, v85, v69, s62
    v_perm_b32 v114, v85, v69, s63
    v_perm_b32 v99, v117, v101, s62
    v_perm_b32 v115, v117, v101, s63
    s_waitcnt vmcnt(4)
    v_perm_b32 v68, v86, v70, s62
    v_perm_b32 v84, v86, v70, s63
    v_perm_b32 v69, v118, v102, s62
    v_perm_b32 v85, v118, v102, s63
    v_perm_b32 v100, v87, v71, s62
    v_perm_b32 v116, v87, v71, s63
    v_perm_b32 v101, v119, v103, s62
    v_perm_b32 v117, v119, v103, s63
    s_waitcnt vmcnt(0)
    v_perm_b32 v70, v88, v72, s62
    v_perm_b32 v86, v88, v72, s63
    v_perm_b32 v71, v120, v104, s62
    v_perm_b32 v87, v120, v104, s63
    v_perm_b32 v102, v89, v73, s62
    v_perm_b32 v118, v89, v73, s63
    v_perm_b32 v103, v121, v105, s62
    v_perm_b32 v119, v121, v105, s63
    s_barrier
    buffer_load_dwordx2 v[88:89], v26, s[48:51], s78 offen sc1
    buffer_load_dwordx4 v[72:75], v25, s[48:51], s77 offen sc1
    buffer_load_dwordx4 v[76:79], v25, s[48:51], s77 offen offset:1024 sc1
    buffer_load_dwordx4 v[32:35], v25, s[48:51], s60 offen sc1
    buffer_load_dwordx4 v[36:39], v25, s[48:51], s60 offen offset:1024 sc1
    s_barrier
    s_branch G3L_zero
G3L_out:
    s_mov_b32 s72, 0
    s_waitcnt vmcnt(0)
    s_branch G3L_go
G3L_re:
    s_cmp_eq_u32 s82, 0
    s_cbranch_scc1 G3_again
    buffer_load_dwordx2 v[88:89], v26, s[48:51], s78 offen sc1
    buffer_load_dwordx4 v[72:75], v25, s[48:51], s77 offen sc1
    buffer_load_dwordx4 v[76:79], v25, s[48:51], s77 offen offset:1024 sc1
    buffer_load_dwordx4 v[32:35], v25, s[48:51], s60 offen sc1
    buffer_load_dwordx4 v[36:39], v25, s[48:51], s60 offen offset:1024 sc1
G3L_zero:
    v_mov_b64 v[4:5], 0
    v_mov_b64 v[28:29], 0
G3L_loop:
    buffer_load_dwordx2 v[88:89], v26, s[48:51], s78 offen sc1
    buffer_load_dwordx4 v[72:75], v25, s[48:51], s77 offen sc1
    buffer_load_dwordx4 v[76:79], v25, s[48:51], s77 offen offset:1024 sc1
    buffer_load_dwordx4 v[32:35], v25, s[48:51], s60 offen sc1
    buffer_load_dwordx4 v[36:39], v25, s[48:51], s60 offen offset:1024 sc1
    s_sub_u32 s72, s72, 1
    s_cbranch_scc1 G3L_out
    s_waitcnt vmcnt(5)
    v_max3_u32 v14, v75, v79, v89
    v_max3_u32 v14, v14, v35, v39
    v_cmp_eq_u32 vcc, -1, v14
    s_cbranch_vccnz G3L_loop
G3L_go:
    v_smfmac_f32_16x16x64_bf16 v[28:31], v[16:19], v[32:39], v24
    s_branch G3_go
ST2_B:
    s_barrier
ST2_C:
    v_mov_b32 v48, 0
    v_mov_b32 v50, 0
    v_mov_b32 v52, 0
    v_mov_b32 v54, 0
    v_mov_b32 v56, 0
    v_mov_b32 v58, 0
    v_mov_b32 v60, 0
    v_mov_b32 v62, 0
    s_mov_b32 s61, 0x3727c5ac
    s_branch G3_pre
G3_out:
    s_mov_b32 s72, 0
    s_waitcnt vmcnt(0)
    s_branch G3_go
G3_retry:
    s_sub_u32 s72, s72, 1
    s_cbranch_scc0 G3L_re
    s_mov_b32 s72, 0
    s_branch G3_ok
G3_pre:
    s_barrier
    buffer_load_dwordx2 v[88:89], v26, s[48:51], s78 offen sc1
    buffer_load_dwordx4 v[72:75], v25, s[48:51], s77 offen sc1
    buffer_load_dwordx4 v[76:79], v25, s[48:51], s77 offen offset:1024 sc1
    s_barrier
    s_branch G3_zero
G3_again:
    buffer_load_dwordx2 v[88:89], v26, s[48:51], s78 offen sc1
    buffer_load_dwordx4 v[72:75], v25, s[48:51], s77 offen sc1
    buffer_load_dwordx4 v[76:79], v25, s[48:51], s77 offen offset:1024 sc1
G3_zero:
    v_mov_b64 v[4:5], 0
G3_loop:
    buffer_load_dwordx2 v[88:89], v26, s[48:51], s78 offen sc1
    buffer_load_dwordx4 v[72:75], v25, s[48:51], s77 offen sc1
    buffer_load_dwordx4 v[76:79], v25, s[48:51], s77 offen offset:1024 sc1
    s_sub_u32 s72, s72, 1
    s_cbranch_scc1 G3_out
    s_waitcnt vmcnt(3)
    v_max3_u32 v14, v75, v79, v89
    v_cmp_eq_u32 vcc, -1, v14
    s_cbranch_vccnz G3_loop
G3_go:
    v_smfmac_f32_16x16x64_bf16 v[4:7], v[16:19], v[72:79], v24
    v_add_f32_dpp v8, v88, v88 row_ror:4 row_mask:0xf bank_mask:0xf
    v_add_f32_dpp v9, v89, v89 row_ror:4 row_mask:0xf bank_mask:0xf
    s_nop 0
    v_add_f32_dpp v8, v8, v8 row_ror:2 row_mask:0xf bank_mask:0xf
    v_add_f32_dpp v9, v9, v9 row_ror:2 row_mask:0xf bank_mask:0xf
    s_nop 0
    v_add_f32_dpp v8, v8, v8 row_ror:1 row_mask:0xf bank_mask:0xf
    v_add_f32_dpp v9, v9, v9 row_ror:1 row_mask:0xf bank_mask:0xf
    v_mul_f32 v8, 0x3b000000, v8
    v_mul_f32 v9, 0x3b000000, v9
    v_fma_f32 v9, -v8, v8, v9
    v_add_f32_e64 v9, |v9|, s61
    v_rsq_f32 v9, v9
    v_fma_f32 v4, -v8, v28, v4
    v_fma_f32 v5, -v8, v29, v5
    v_mul_f32 v4, v4, v9
    v_mul_f32 v5, v5, v9
    v_cmp_u_f32 vcc, v4, v5
    v_mul_f32 v6, 0xbfb8aa3b, v4
    s_cbranch_vccnz G3_retry
G3_ok:
    v_exp_f32 v6, v6
    v_mul_f32 v4, v4, v5
    v_add_f32 v6, 1.0, v6
    v_rcp_f32 v6, v6
    s_nop 0
    v_mul_f32 v4, v4, v6
    s_nop 1
    v_mov_b32_dpp v5, v4 row_shl:1 row_mask:0xf bank_mask:0xf
    v_cvt_pk_bf16_f32 v8, v4, v5
    s_nop 1
    v_mov_b32_dpp v9, v8 row_shl:4 row_mask:0xf bank_mask:0xf
    v_mov_b32_dpp v10, v8 row_shl:8 row_mask:0xf bank_mask:0xf
    v_mov_b32_dpp v11, v8 row_shl:12 row_mask:0xf bank_mask:0xf
    s_nop 1
    v_smfmac_f32_16x16x64_bf16 v[48:51], v[8:11], v[64:71], v1
    v_smfmac_f32_16x16x64_bf16 v[52:55], v[8:11], v[80:87], v1
    v_smfmac_f32_16x16x64_bf16 v[56:59], v[8:11], v[96:103], v1
    v_smfmac_f32_16x16x64_bf16 v[60:63], v[8:11], v[112:119], v1
    v_add_f32 v48, v48, v50
    v_add_f32 v52, v52, v54
    v_cvt_pk_bf16_f32 v4, v48, v52
    s_nop 0
    v_add_f32 v56, v56, v58
    s_nop 2
    v_add_f32 v60, v60, v62
    v_cvt_pk_bf16_f32 v5, v56, v60
    s_mov_b64 exec, s[66:67]
    buffer_store_dwordx2 v[4:5], v20, s[48:51], s79 offen sc1
    s_mov_b64 exec, s[64:65]
    s_waitcnt vmcnt(0)
    s_barrier
    s_cbranch_execnz END2
ST3:
    s_cmp_eq_u32 s80, 0
    s_cbranch_scc0 ST3_B
    s_barrier
    v_mov_b64 v[4:5], 0
    s_waitcnt vmcnt(0)
    s_nop 0
    v_smfmac_f32_16x16x64_bf16 v[4:7], v[16:19], v[32:39], v24
    s_nop 7
    v_mov_b64 v[28:29], v[4:5]
ST3_B:
    s_barrier
    s_barrier
    s_barrier
    v_and_b32 v12, 0xffffff7f, v25
    ds_read_b32 v12, v12 offset:4608
    v_mov_b64 v[48:49], 0
    v_mov_b64 v[52:53], 0
    v_mov_b64 v[56:57], 0
    v_mov_b64 v[60:61], 0
    s_waitcnt lgkmcnt(0)
    v_lshlrev_b32 v14, 16, v12
    v_and_b32 v15, 0xffff0000, v12
    v_mul_f32 v14, 0.5, v14
    v_mul_f32 v15, 0.5, v15
    s_mov_b32 s61, 0x3727c5ac
    s_branch G4_pre
G4_retry:
    s_sub_u32 s72, s72, 1
    s_cbranch_scc0 G4_loop
    s_mov_b32 s72, 0
    s_branch G4_ok
G4_pre:
    s_barrier
G4_loop:
    buffer_load_dwordx4 v[32:35], v25, s[48:51], s74 offen offset:0 sc1
    buffer_load_dwordx4 v[36:39], v25, s[48:51], s74 offen offset:1024 sc1
    buffer_load_dwordx4 v[40:43], v25, s[48:51], s74 offen offset:2048 sc1
    buffer_load_dwordx4 v[44:47], v25, s[48:51], s74 offen offset:3072 sc1
G4_wait:
    v_mov_b64 v[4:5], v[14:15]
    s_waitcnt vmcnt(2)
G4_chk:
    s_nop 0
    v_smfmac_f32_16x16x64_bf16 v[4:7], v[16:19], v[32:39], v24
    s_waitcnt vmcnt(0)
    v_smfmac_f32_16x16x64_bf16 v[4:7], v[16:19], v[40:47], v24
    v_mov_b64 v[32:33], 0
    v_mov_b64 v[36:37], 0
    v_mov_b64 v[40:41], 0
    v_mov_b64 v[44:45], 0
    s_nop 3
    v_add_f32_dpp v4, v4, v4 row_ror:8 row_mask:0xf bank_mask:0xf
    v_add_f32_dpp v5, v5, v5 row_ror:8 row_mask:0xf bank_mask:0xf
    v_cmp_u_f32 vcc, v4, v5
    v_cvt_pk_bf16_f32 v8, v4, v5
    s_cbranch_vccnz G4_retry
G4_ok:
    s_cmp_eq_u32 s80, 1
    s_cbranch_scc1 FINAL
    s_cmp_eq_u32 s73, 1
    v_mov_b32_dpp v9, v8 row_shl:2 row_mask:0xf bank_mask:0xf
    v_mov_b32_dpp v10, v8 row_shl:4 row_mask:0xf bank_mask:0xf
    v_mov_b32_dpp v11, v8 row_shl:6 row_mask:0xf bank_mask:0xf
    ds_write_b32 v25, v8 offset:4608
    s_nop 0
    v_mfma_f32_16x16x32_bf16 v[4:7], v[8:11], v[8:11], 0
    v_mfma_f32_16x16x32_bf16 v[12:15], v[8:11], v[20:23], 0
    v_smfmac_f32_16x16x64_bf16 v[32:35], v[8:11], v[64:71], v1
    v_smfmac_f32_16x16x64_bf16 v[36:39], v[8:11], v[72:79], v1
    v_smfmac_f32_16x16x64_bf16 v[40:43], v[8:11], v[80:87], v1
    v_add_f32_dpp v5, v5, v4 row_shl:1 row_mask:0xf bank_mask:0xf
    v_smfmac_f32_16x16x64_bf16 v[44:47], v[8:11], v[88:95], v1
    v_add_f32 v4, v12, v13
    v_smfmac_f32_16x16x64_bf16 v[48:51], v[8:11], v[96:103], v1
    v_add_f32 v32, v32, v33
    v_smfmac_f32_16x16x64_bf16 v[52:55], v[8:11], v[104:111], v1
    v_add_f32 v36, v36, v37
    v_smfmac_f32_16x16x64_bf16 v[56:59], v[8:11], v[112:119], v1
    v_add_f32 v40, v40, v41
    v_smfmac_f32_16x16x64_bf16 v[60:63], v[8:11], v[120:127], v1
    v_add_f32 v44, v44, v45
    v_add_f32 v48, v48, v49
    v_cvt_pk_bf16_f32 v32, v32, v36
    v_add_f32 v52, v52, v53
    v_cvt_pk_bf16_f32 v33, v40, v44
    v_add_f32 v56, v56, v57
    v_cvt_pk_bf16_f32 v34, v48, v52
    s_mov_b64 exec, s[66:67]
    v_add_f32 v60, v60, v61
    v_cvt_pk_bf16_f32 v35, v56, v60
    s_cbranch_scc0 slow_5
    buffer_store_dwordx4 v[32:35], v25, s[48:51], s75 offen
    s_mov_b64 exec, s[68:69]
    buffer_store_dwordx2 v[4:5], v25, s[48:51], s76 offen
    s_cbranch_execnz sent_6
slow_5:
    buffer_store_dwordx4 v[32:35], v25, s[48:51], s75 offen sc1
    s_mov_b64 exec, s[68:69]
    buffer_store_dwordx2 v[4:5], v25, s[48:51], s76 offen sc1
sent_6:
    s_mov_b64 exec, s[64:65]
    s_branch G5_pre
G5_out:
    s_mov_b32 s72, 0
    s_waitcnt vmcnt(0)
    s_branch G5_go
G5_retry:
    s_sub_u32 s72, s72, 1
    s_cbranch_scc0 G5_again
    s_mov_b32 s72, 0
    s_branch G5_ok
G5_pre:
G5_again:
    buffer_load_dwordx2 v[88:89], v26, s[48:51], s78 offen sc1
    buffer_load_dwordx4 v[72:75], v25, s[48:51], s77 offen sc1
    buffer_load_dwordx4 v[76:79], v25, s[48:51], s77 offen offset:1024 sc1
    v_mov_b32 v32, 0
    v_mov_b32 v34, 0
    v_mov_b32 v36, 0
    v_mov_b32 v38, 0
    v_mov_b32 v40, 0
    v_mov_b32 v42, 0
    v_mov_b32 v44, 0
    v_mov_b32 v46, 0
    v_mov_b64 v[48:49], 0
    v_mov_b64 v[50:51], 0
    v_mov_b64 v[52:53], 0
    v_mov_b64 v[54:55], 0
    v_mov_b64 v[56:57], 0
    v_mov_b64 v[58:59], 0
    v_mov_b64 v[60:61], 0
    v_mov_b64 v[62:63], 0
    v_mov_b32 v13, 0
    s_waitcnt vmcnt(3)
    v_mov_b64 v[4:5], 0
G5_loop:
    buffer_load_dwordx2 v[88:89], v26, s[48:51], s78 offen sc1
    buffer_load_dwordx4 v[72:75], v25, s[48:51], s77 offen sc1
    buffer_load_dwordx4 v[76:79], v25, s[48:51], s77 offen offset:1024 sc1
    s_sub_u32 s72, s72, 1
    s_cbranch_scc1 G5_out
    s_waitcnt vmcnt(3)
    v_max3_u32 v14, v75, v79, v89
    v_cmp_eq_u32 vcc, -1, v14
    s_cbranch_vccnz G5_loop
G5_go:
    v_smfmac_f32_16x16x64_bf16 v[4:7], v[16:19], v[72:79], v24
    v_add_f32_dpp v8, v88, v88 row_ror:4 row_mask:0xf bank_mask:0xf
    v_add_f32_dpp v9, v89, v89 row_ror:4 row_mask:0xf bank_mask:0xf
    s_nop 0
    v_add_f32_dpp v8, v8, v8 row_ror:2 row_mask:0xf bank_mask:0xf
    v_add_f32_dpp v9, v9, v9 row_ror:2 row_mask:0xf bank_mask:0xf
    s_nop 0
    v_add_f32_dpp v8, v8, v8 row_ror:1 row_mask:0xf bank_mask:0xf
    v_add_f32_dpp v9, v9, v9 row_ror:1 row_mask:0xf bank_mask:0xf
    v_mul_f32 v8, 0x3b000000, v8
    v_mul_f32 v9, 0x3b000000, v9
    v_fma_f32 v9, -v8, v8, v9
    v_add_f32_e64 v9, |v9|, s61
    v_rsq_f32 v9, v9
    v_fma_f32 v4, -v8, v28, v4
    v_fma_f32 v5, -v8, v29, v5
    v_mul_f32 v9, 0x3e0293ee, v9
    v_mul_f32 v4, v4, v9
    v_mul_f32 v5, v5, v9
    v_cmp_u_f32 vcc, v4, v5
    v_cvt_pk_bf16_f32 v4, v4, v5
    s_cbranch_vccnz G5_retry
G5_ok:
    ds_write_b32 v27, v4 offset:4352
    s_add_u32 s74, s74, 131072
    s_mov_b32 s80, 1
    s_branch ATT_Z
FINAL:
    buffer_store_dword v8, v31, s[40:43], s83 offen
    s_endpgm
NOT0:
    s_cmp_eq_u32 s3, 1
    s_cbranch_scc1 ST1
    s_cmp_eq_u32 s3, 2
    s_cbranch_scc1 ST2
    s_cmp_eq_u32 s80, 0
    s_cbranch_scc1 NOT0_A
    s_cmp_eq_u32 s3, 3
    s_cselect_b32 s60, s5, 63
    s_cmp_eq_u32 s60, 0
    s_cbranch_scc1 ST3
    s_endpgm
NOT0_A:
    s_cmp_eq_u32 s3, 3
    s_cbranch_scc1 ST3
    s_barrier
    s_barrier
END0:
    s_cmp_eq_u32 s80, 1
    s_cbranch_scc1 END
    s_barrier
    s_barrier
    s_barrier
    s_add_u32 s75, s75, 131072
    s_add_u32 s76, s76, 16
    s_add_u32 s77, s77, 131072
    s_add_u32 s78, s78, 16
    s_add_u32 s79, s79, 131072
    s_mov_b32 s80, 1
    s_mov_b32 s81, 0
    s_mov_b32 s82, 0
    s_branch ATT
END1:
    s_cmp_eq_u32 s80, 1
    s_cbranch_scc1 END
    s_barrier
    s_mov_b32 s67, 0
    s_add_u32 s74, s74, 131072
    s_add_u32 s75, s75, 131072
    s_add_u32 s76, s76, 16
    s_mov_b32 s80, 1
    s_mov_b32 s81, 0
    s_mov_b32 s82, 0
    s_branch ATT
END2:
    s_cmp_eq_u32 s80, 1
    s_cbranch_scc1 END
    s_add_u32 s77, s77, 131072
    s_add_u32 s78, s78, 16
    s_add_u32 s79, s79, 131072
    s_mov_b32 s80, 1
    s_mov_b32 s81, 0
    s_mov_b32 s82, 0
    s_branch ATT
SMAX:
    s_mov_b32 s60, 0x42000000
    v_cmp_nle_f32_e64 vcc, |v12|, s60
    s_cbranch_vccz VT
    v_add_f32 v4, v49, v51
    v_add_f32 v5, v53, v55
    v_add_f32 v6, v57, v59
    v_add_f32 v7, v61, v63
    v_max3_f32 v13, v4, v5, v6
    v_max_f32 v13, v13, v7
    s_nop 1
    v_max_f32_dpp v13, v13, v13 row_ror:8 row_mask:0xf bank_mask:0xf
    s_nop 1
    v_max_f32_dpp v13, v13, v13 row_ror:4 row_mask:0xf bank_mask:0xf
    s_nop 1
    v_max_f32_dpp v13, v13, v13 row_ror:2 row_mask:0xf bank_mask:0xf
    s_nop 1
    v_max_f32_dpp v13, v13, v13 row_ror:1 row_mask:0xf bank_mask:0xf
    v_sub_f32 v5, v12, v13
    v_exp_f32 v5, v5
    s_nop 1
    v_mov_b32_dpp v6, v5 row_shl:4 row_mask:0xf bank_mask:0xf
    v_cvt_pk_bf16_f32 v8, v5, v6
    v_add_f32_dpp v5, v5, v5 row_ror:8 row_mask:0xf bank_mask:0xf
    s_nop 0
    v_mov_b32_dpp v9, v8 row_shl:8 row_mask:0xf bank_mask:0xf
    v_mov_b32_dpp v10, v8 row_shl:1 row_mask:0xf bank_mask:0xf
    v_mov_b32_dpp v11, v8 row_shl:9 row_mask:0xf bank_mask:0xf
    v_add_f32_dpp v5, v5, v5 row_ror:4 row_mask:0xf bank_mask:0xf
    s_cbranch_scc1 PV
VT:
    s_waitcnt vmcnt(13)
    v_permlane32_swap_b32 v196, v212
    v_permlane32_swap_b32 v197, v213
    v_permlane32_swap_b32 v198, v214
    v_permlane32_swap_b32 v199, v215
    v_permlane32_swap_b32 v204, v220
    v_permlane32_swap_b32 v205, v221
    v_permlane32_swap_b32 v206, v222
    v_permlane32_swap_b32 v207, v223
    v_perm_b32 v192, v204, v196, s62
    v_perm_b32 v200, v204, v196, s63
    v_perm_b32 v193, v220, v212, s62
    v_perm_b32 v201, v220, v212, s63
    v_perm_b32 v208, v205, v197, s62
    v_perm_b32 v216, v205, v197, s63
    v_perm_b32 v209, v221, v213, s62
    v_perm_b32 v217, v221, v213, s63
    v_perm_b32 v224, v206, v198, s62
    v_perm_b32 v232, v206, v198, s63
    v_perm_b32 v225, v222, v214, s62
    v_perm_b32 v233, v222, v214, s63
    v_perm_b32 v240, v207, v199, s62
    v_perm_b32 v248, v207, v199, s63
    v_perm_b32 v241, v223, v215, s62
    v_perm_b32 v249, v223, v215, s63
    s_waitcnt vmcnt(9)
    v_permlane32_swap_b32 v228, v244
    v_permlane32_swap_b32 v229, v245
    v_permlane32_swap_b32 v230, v246
    v_permlane32_swap_b32 v231, v247
    v_permlane32_swap_b32 v236, v252
    v_permlane32_swap_b32 v237, v253
    v_permlane32_swap_b32 v238, v254
    v_permlane32_swap_b32 v239, v255
    v_perm_b32 v194, v236, v228, s62
    v_perm_b32 v202, v236, v228, s63
    v_perm_b32 v195, v252, v244, s62
    v_perm_b32 v203, v252, v244, s63
    v_perm_b32 v210, v237, v229, s62
    v_perm_b32 v218, v237, v229, s63
    v_perm_b32 v211, v253, v245, s62
    v_perm_b32 v219, v253, v245, s63
    v_perm_b32 v226, v238, v230, s62
    v_perm_b32 v234, v238, v230, s63
    v_perm_b32 v227, v254, v246, s62
    v_perm_b32 v235, v254, v246, s63
    v_perm_b32 v242, v239, v231, s62
    v_perm_b32 v250, v239, v231, s63
    v_perm_b32 v243, v255, v247, s62
    v_perm_b32 v251, v255, v247, s63
    s_waitcnt vmcnt(5)
    v_permlane32_swap_b32 v64, v72
    v_permlane32_swap_b32 v65, v73
    v_permlane32_swap_b32 v66, v74
    v_permlane32_swap_b32 v67, v75
    v_permlane32_swap_b32 v68, v76
    v_permlane32_swap_b32 v69, v77
    v_permlane32_swap_b32 v70, v78
    v_permlane32_swap_b32 v71, v79
    v_perm_b32 v196, v68, v64, s62
    v_perm_b32 v204, v68, v64, s63
    v_perm_b32 v197, v76, v72, s62
    v_perm_b32 v205, v76, v72, s63
    v_perm_b32 v212, v69, v65, s62
    v_perm_b32 v220, v69, v65, s63
    v_perm_b32 v213, v77, v73, s62
    v_perm_b32 v221, v77, v73, s63
    v_perm_b32 v228, v70, v66, s62
    v_perm_b32 v236, v70, v66, s63
    v_perm_b32 v229, v78, v74, s62
    v_perm_b32 v237, v78, v74, s63
    v_perm_b32 v244, v71, v67, s62
    v_perm_b32 v252, v71, v67, s63
    v_perm_b32 v245, v79, v75, s62
    v_perm_b32 v253, v79, v75, s63
    s_waitcnt vmcnt(1)
    v_permlane32_swap_b32 v80, v88
    v_permlane32_swap_b32 v81, v89
    v_permlane32_swap_b32 v82, v90
    v_permlane32_swap_b32 v83, v91
    v_permlane32_swap_b32 v84, v92
    v_permlane32_swap_b32 v85, v93
    v_permlane32_swap_b32 v86, v94
    v_permlane32_swap_b32 v87, v95
    v_perm_b32 v198, v84, v80, s62
    v_perm_b32 v206, v84, v80, s63
    v_perm_b32 v199, v92, v88, s62
    v_perm_b32 v207, v92, v88, s63
    v_perm_b32 v214, v85, v81, s62
    v_perm_b32 v222, v85, v81, s63
    v_perm_b32 v215, v93, v89, s62
    v_perm_b32 v223, v93, v89, s63
    v_perm_b32 v230, v86, v82, s62
    v_perm_b32 v238, v86, v82, s63
    v_perm_b32 v231, v94, v90, s62
    v_perm_b32 v239, v94, v90, s63
    v_perm_b32 v246, v87, v83, s62
    v_perm_b32 v254, v87, v83, s63
    v_perm_b32 v247, v95, v91, s62
    v_perm_b32 v255, v95, v91, s63
    s_branch PV
WL:
    s_cmp_eq_u32 s3, 0
    s_cbranch_scc1 WL0
    s_cmp_eq_u32 s3, 2
    s_cbranch_scc1 WL2
    s_cmp_eq_u32 s3, 3
    s_cbranch_scc0 B2
    s_add_u32 s60, s77, 393216
    s_mov_b32 s82, 0
    s_waitcnt lgkmcnt(0)
    buffer_load_dwordx4 v[32:35], v25, s[48:51], s60 offen sc1
    buffer_load_dwordx4 v[36:39], v25, s[48:51], s60 offen offset:1024 sc1
    s_setprio 0
    s_branch B2
WL0:
    s_mov_b32 s60, 0
    buffer_load_dwordx2 v[66:67], v3, s[24:27], s60 offen offset:0 nt
    buffer_load_dwordx2 v[82:83], v3, s[24:27], s60 offen offset:1024 nt
    buffer_load_dwordx2 v[98:99], v3, s[24:27], s60 offen offset:2048 nt
    buffer_load_dwordx2 v[114:115], v3, s[24:27], s60 offen offset:3072 nt
    s_mov_b32 s60, 4096
    buffer_load_dwordx2 v[68:69], v3, s[24:27], s60 offen offset:0 nt
    buffer_load_dwordx2 v[84:85], v3, s[24:27], s60 offen offset:1024 nt
    buffer_load_dwordx2 v[100:101], v3, s[24:27], s60 offen offset:2048 nt
    buffer_load_dwordx2 v[116:117], v3, s[24:27], s60 offen offset:3072 nt
    s_mov_b32 s60, 32768
    buffer_load_dwordx2 v[70:71], v3, s[24:27], s60 offen offset:0 nt
    buffer_load_dwordx2 v[86:87], v3, s[24:27], s60 offen offset:1024 nt
    buffer_load_dwordx2 v[102:103], v3, s[24:27], s60 offen offset:2048 nt
    buffer_load_dwordx2 v[118:119], v3, s[24:27], s60 offen offset:3072 nt
    s_mov_b32 s60, 36864
    buffer_load_dwordx2 v[72:73], v3, s[24:27], s60 offen offset:0 nt
    buffer_load_dwordx2 v[88:89], v3, s[24:27], s60 offen offset:1024 nt
    buffer_load_dwordx2 v[104:105], v3, s[24:27], s60 offen offset:2048 nt
    buffer_load_dwordx2 v[120:121], v3, s[24:27], s60 offen offset:3072 nt
    s_mov_b32 s60, 65536
    buffer_load_dwordx2 v[74:75], v3, s[24:27], s60 offen offset:0 nt
    buffer_load_dwordx2 v[90:91], v3, s[24:27], s60 offen offset:1024 nt
    buffer_load_dwordx2 v[106:107], v3, s[24:27], s60 offen offset:2048 nt
    buffer_load_dwordx2 v[122:123], v3, s[24:27], s60 offen offset:3072 nt
    s_mov_b32 s60, 69632
    buffer_load_dwordx2 v[76:77], v3, s[24:27], s60 offen offset:0 nt
    buffer_load_dwordx2 v[92:93], v3, s[24:27], s60 offen offset:1024 nt
    buffer_load_dwordx2 v[108:109], v3, s[24:27], s60 offen offset:2048 nt
    buffer_load_dwordx2 v[124:125], v3, s[24:27], s60 offen offset:3072 nt
    s_mov_b32 s60, 98304
    buffer_load_dwordx2 v[78:79], v3, s[24:27], s60 offen offset:0 nt
    buffer_load_dwordx2 v[94:95], v3, s[24:27], s60 offen offset:1024 nt
    buffer_load_dwordx2 v[110:111], v3, s[24:27], s60 offen offset:2048 nt
    buffer_load_dwordx2 v[126:127], v3, s[24:27], s60 offen offset:3072 nt
    s_mov_b32 s60, 102400
    buffer_load_dwordx2 v[20:21], v3, s[24:27], s60 offen offset:0 nt
    buffer_load_dwordx2 v[22:23], v3, s[24:27], s60 offen offset:1024 nt
    buffer_load_dwordx2 v[28:29], v3, s[24:27], s60 offen offset:2048 nt
    buffer_load_dwordx2 v[30:31], v3, s[24:27], s60 offen offset:3072 nt
    v_bfe_u32 v3, v25, 4, 4
    v_lshlrev_b32 v3, 3, v3
    v_lshrrev_b32 v12, 8, v25
    v_lshl_add_u32 v3, v12, 1, v3
    s_branch B2
WL1:
    s_mov_b32 s60, 0
    buffer_load_dwordx2 v[66:67], v3, s[28:31], s60 offen offset:0 nt
    buffer_load_dwordx2 v[82:83], v3, s[28:31], s60 offen offset:2752 nt
    s_mov_b32 s60, 22016
    buffer_load_dwordx2 v[98:99], v3, s[28:31], s60 offen offset:0 nt
    buffer_load_dwordx2 v[114:115], v3, s[28:31], s60 offen offset:2752 nt
    s_mov_b32 s60, 44032
    buffer_load_dwordx2 v[68:69], v3, s[28:31], s60 offen offset:0 nt
    buffer_load_dwordx2 v[84:85], v3, s[28:31], s60 offen offset:2752 nt
    s_mov_b32 s60, 66048
    buffer_load_dwordx2 v[100:101], v3, s[28:31], s60 offen offset:0 nt
    buffer_load_dwordx2 v[116:117], v3, s[28:31], s60 offen offset:2752 nt
    s_mov_b32 s60, 11008
    buffer_load_dwordx2 v[70:71], v3, s[28:31], s60 offen offset:0 nt
    buffer_load_dwordx2 v[86:87], v3, s[28:31], s60 offen offset:2752 nt
    s_mov_b32 s60, 33024
    buffer_load_dwordx2 v[102:103], v3, s[28:31], s60 offen offset:0 nt
    buffer_load_dwordx2 v[118:119], v3, s[28:31], s60 offen offset:2752 nt
    s_mov_b32 s60, 55040
    buffer_load_dwordx2 v[72:73], v3, s[28:31], s60 offen offset:0 nt
    buffer_load_dwordx2 v[88:89], v3, s[28:31], s60 offen offset:2752 nt
    s_mov_b32 s60, 77056
    buffer_load_dwordx2 v[104:105], v3, s[28:31], s60 offen offset:0 nt
    buffer_load_dwordx2 v[120:121], v3, s[28:31], s60 offen offset:2752 nt
    s_mov_b32 s60, 0
    buffer_load_dwordx2 v[74:75], v3, s[32:35], s60 offen offset:0 nt
    buffer_load_dwordx2 v[90:91], v3, s[32:35], s60 offen offset:2752 nt
    s_mov_b32 s60, 22016
    buffer_load_dwordx2 v[106:107], v3, s[32:35], s60 offen offset:0 nt
    buffer_load_dwordx2 v[122:123], v3, s[32:35], s60 offen offset:2752 nt
    s_barrier
    s_mov_b32 s60, 44032
    buffer_load_dwordx2 v[76:77], v3, s[32:35], s60 offen offset:0 nt
    buffer_load_dwordx2 v[92:93], v3, s[32:35], s60 offen offset:2752 nt
    s_mov_b32 s60, 66048
    buffer_load_dwordx2 v[108:109], v3, s[32:35], s60 offen offset:0 nt
    buffer_load_dwordx2 v[124:125], v3, s[32:35], s60 offen offset:2752 nt
    s_mov_b32 s60, 11008
    buffer_load_dwordx2 v[78:79], v3, s[32:35], s60 offen offset:0 nt
    buffer_load_dwordx2 v[94:95], v3, s[32:35], s60 offen offset:2752 nt
    s_mov_b32 s60, 33024
    buffer_load_dwordx2 v[110:111], v3, s[32:35], s60 offen offset:0 nt
    buffer_load_dwordx2 v[126:127], v3, s[32:35], s60 offen offset:2752 nt
    s_mov_b32 s60, 55040
    buffer_load_dwordx2 v[20:21], v3, s[32:35], s60 offen offset:0 nt
    buffer_load_dwordx2 v[22:23], v3, s[32:35], s60 offen offset:2752 nt
    s_mov_b32 s60, 77056
    buffer_load_dwordx2 v[28:29], v3, s[32:35], s60 offen offset:0 nt
    buffer_load_dwordx2 v[30:31], v3, s[32:35], s60 offen offset:2752 nt
    s_branch WB1
WL2:
    s_mov_b32 s60, 0
    buffer_load_dwordx2 v[66:67], v3, s[36:39], s60 offen offset:0 nt
    s_mov_b32 s60, 4096
    buffer_load_dwordx2 v[82:83], v3, s[36:39], s60 offen offset:0 nt
    s_mov_b32 s60, 8192
    buffer_load_dwordx2 v[98:99], v3, s[36:39], s60 offen offset:0 nt
    s_mov_b32 s60, 12288
    buffer_load_dwordx2 v[114:115], v3, s[36:39], s60 offen offset:0 nt
    s_mov_b32 s60, 16384
    buffer_load_dwordx2 v[68:69], v3, s[36:39], s60 offen offset:0 nt
    s_mov_b32 s60, 20480
    buffer_load_dwordx2 v[84:85], v3, s[36:39], s60 offen offset:0 nt
    s_mov_b32 s60, 24576
    buffer_load_dwordx2 v[100:101], v3, s[36:39], s60 offen offset:0 nt
    s_mov_b32 s60, 28672
    buffer_load_dwordx2 v[116:117], v3, s[36:39], s60 offen offset:0 nt
    s_mov_b32 s60, 0
    buffer_load_dwordx2 v[70:71], v3, s[36:39], s60 offen offset:2048 nt
    s_mov_b32 s60, 4096
    buffer_load_dwordx2 v[86:87], v3, s[36:39], s60 offen offset:2048 nt
    s_mov_b32 s60, 8192
    buffer_load_dwordx2 v[102:103], v3, s[36:39], s60 offen offset:2048 nt
    s_mov_b32 s60, 12288
    buffer_load_dwordx2 v[118:119], v3, s[36:39], s60 offen offset:2048 nt
    s_mov_b32 s60, 16384
    buffer_load_dwordx2 v[72:73], v3, s[36:39], s60 offen offset:2048 nt
    s_mov_b32 s60, 20480
    buffer_load_dwordx2 v[88:89], v3, s[36:39], s60 offen offset:2048 nt
    s_mov_b32 s60, 24576
    buffer_load_dwordx2 v[104:105], v3, s[36:39], s60 offen offset:2048 nt
    s_mov_b32 s60, 28672
    buffer_load_dwordx2 v[120:121], v3, s[36:39], s60 offen offset:2048 nt
    s_branch B2
MERGE:
    v_max_f32_dpp v7, v4, v4 row_ror:4 row_mask:0xf bank_mask:0xf
    s_nop 1
    v_max_f32_dpp v7, v7, v7 row_ror:2 row_mask:0xf bank_mask:0xf
    s_nop 1
    v_max_f32_dpp v7, v7, v7 row_ror:1 row_mask:0xf bank_mask:0xf
    v_sub_f32 v4, v4, v7
    v_exp_f32 v4, v4
    s_nop 0
    v_cvt_pk_bf16_f32 v4, v4, v4
    v_lshrrev_b32 v6, 16, v4
    v_and_b32 v4, 0xffff0000, v4
    v_mul_f32 v5, v5, v4
    v_mov_b32 v4, v7
    v_mov_b32_dpp v12, v6 row_newbcast:0 row_mask:0xf bank_mask:0xf
    v_mov_b32_dpp v13, v6 row_newbcast:1 row_mask:0xf bank_mask:0xf
    v_lshrrev_b32 v6, 7, v16
    v_lshrrev_b32 v7, 7, v17
    v_and_b32 v6, 0x10001, v6
    v_and_b32 v7, 0x10001, v7
    v_mul_u32_u24 v8, v6, v12
    v_mul_u32_u24 v9, v7, v12
    v_mul_u32_u24 v10, v6, v13
    v_mul_u32_u24 v11, v7, v13
    v_mov_b64 v[32:33], 0
    s_nop 1
    v_smfmac_f32_16x16x64_bf16 v[32:35], v[8:11], v[40:47], v24
    s_nop 2
    s_branch MERGE_BACK
END:
s_endpgm
.section .rodata,"a"
.p2align 6
.amdhsa_kernel interleave_layers__mha_block_cached__swiglu_ffn__decode_kernel
  .amdhsa_next_free_vgpr 256
  .amdhsa_next_free_sgpr 102
  .amdhsa_accum_offset 256
  .amdhsa_group_segment_fixed_size 0
  .amdhsa_kernarg_size 96
  .amdhsa_user_sgpr_count 2
  .amdhsa_user_sgpr_kernarg_segment_ptr 1
  .amdhsa_system_sgpr_workgroup_id_x 1
.end_amdhsa_kernel
```
